```python
import torch

def _softmax(x, axis=-1):
    return torch.softmax(x, dim=axis)
def _gelu(x):
    return torch.nn.functional.gelu(x, approximate="tanh")
def _silu(x):
    return torch.nn.functional.silu(x)
def _sigmoid(x):
    return torch.sigmoid(x)
def _layernorm(x, axis=-1, eps=1e-5):
    m = x.mean(dim=axis, keepdim=True)
    v = x.var(dim=axis, keepdim=True, unbiased=False)
    return (x - m) / torch.sqrt(v + eps)
def _scatter_add(tgt, idx, src, axis=0):
    return tgt.clone().index_add_(axis, idx, src)
def _segment_sum(src, seg, n):
    out = torch.zeros((n,) + src.shape[1:], dtype=src.dtype)
    return out.index_add_(0, seg, src)
def _pad(x, pw):
    flat = tuple(v for pair in reversed(pw) for v in pair)
    return torch.nn.functional.pad(x, flat)

kernel_name = 'parallel_sum__ssm_conv_s4d__glu_gated_swiglu__prompt'

def setup_inputs():

    _w = (lambda a: (lambda t: t.to(torch.bfloat16) if t.is_floating_point() else t)(torch.as_tensor(a)))
    def _A_setup():
        Bsz, L, D, N = 1, 2048, 512, 128
        return {
            "u": _w((lambda *s: torch.randn(*s, dtype=torch.bfloat16) * 0.05)(Bsz, L, D)),
            "log_A_real": _w((lambda *s: torch.randn(*s, dtype=torch.bfloat16) * 3.2)(D, N) * 0.5),
            "A_imag": _w((lambda *s: torch.randn(*s, dtype=torch.bfloat16) * 0.05)(D, N) * 3.14),
            "C_real": _w((lambda *s: torch.randn(*s, dtype=torch.bfloat16) * 0.1)(D, N) / N ** 0.5),
            "C_imag": _w((lambda *s: torch.randn(*s, dtype=torch.bfloat16) * 0.2)(D, N) / N ** 0.5),
            "log_dt": _w((lambda *s: torch.randn(*s, dtype=torch.bfloat16) * 0.05)(D) * 0.5 - 4.0),
            "D_skip": _w((lambda *s: torch.randn(*s, dtype=torch.bfloat16) * 0.05)(D)),
        }
    _A_in = _A_setup()

    def _B_setup():
        B, S, D, F = 1, 2048, 512, 1792
        return {
            "x": _w((lambda *s: torch.randn(*s, dtype=torch.bfloat16) * 0.05)(B, S, D)),
            "w1": _w((lambda *s: torch.randn(*s, dtype=torch.bfloat16) * 0.4)(D, F) * (2.0 / D) ** 0.5),
            "w3": _w((lambda *s: torch.randn(*s, dtype=torch.bfloat16) * 0.4)(D, F) * (2.0 / D) ** 0.5),
            "w2": _w((lambda *s: torch.randn(*s, dtype=torch.bfloat16) * 0.4)(F, D) * (2.0 / F) ** 0.5),
        }
    _B_in = _B_setup()

    return {
        "A_u": _A_in["u"],
        "A_log_A_real": _A_in["log_A_real"],
        "A_A_imag": _A_in["A_imag"],
        "A_C_real": _A_in["C_real"],
        "A_C_imag": _A_in["C_imag"],
        "A_log_dt": _A_in["log_dt"],
        "A_D_skip": _A_in["D_skip"],
        "B_x": _B_in["x"],
        "B_w1": _B_in["w1"],
        "B_w3": _B_in["w3"],
        "B_w2": _B_in["w2"],
    }

def reference(A_u, A_log_A_real, A_A_imag, A_C_real, A_C_imag, A_log_dt, A_D_skip, B_x, B_w1, B_w3, B_w2):
    def _A_ref(u, log_A_real, A_imag, C_real, C_imag, log_dt, D_skip):
        L = u.shape[1]
        dt = torch.exp(log_dt)
        A = -torch.exp(log_A_real) + 1j * A_imag
        C = (C_real + 1j * C_imag) * dt[:, None]
        pos = (lambda x, dt: x.to(dt))(torch.arange(L), log_dt.dtype)
        P = torch.exp((A * dt[:, None])[:, :, None] * pos[None, None, :])
        K = 2.0 * torch.einsum("dn,dnl->dl", C, P).real
        L2 = 2 * L
        u_t = (lambda x, *d: x.permute(*d))(u, 0, 2, 1)
        Kf = (lambda x, *a, **k: torch.fft.rfft(x.float(), *a, **k))(K, L2)
        Uf = (lambda x, *a, **k: torch.fft.rfft(x.float(), *a, **k))(u_t, L2)
        y = (lambda x, *a, **k: torch.fft.irfft(x, *a, **k).to(torch.bfloat16))(Uf * Kf[None, :, :], L2)[:, :, :L]
        y = (lambda x, *d: x.permute(*d))(y, 0, 2, 1)
        return y + u * D_skip[None, None, :]

    def _B_ref(x, w1, w3, w2):
        gate = torch.einsum("bsd,df->bsf", x, w1)
        up = torch.einsum("bsd,df->bsf", x, w3)
        h = _silu(gate) * up
        out = torch.einsum("bsf,fd->bsd", h, w2)
        return out

    x = A_u
    xn = _layernorm(x, axis=-1)
    return x + _A_ref(xn, A_log_A_real, A_A_imag, A_C_real, A_C_imag, A_log_dt, A_D_skip) + _B_ref(xn, B_w1, B_w3, B_w2)
```

```asm
; @launch grid=(256,1,1) block=(512,1,1) lds=163840
.amdgcn_target "amdgcn-amd-amdhsa--gfx950"
.text
.globl parallel_sum__ssm_conv_s4d__glu_gated_swiglu__prompt_kernel
.p2align 8
.type parallel_sum__ssm_conv_s4d__glu_gated_swiglu__prompt_kernel,@function
parallel_sum__ssm_conv_s4d__glu_gated_swiglu__prompt_kernel:
    s_cmp_ge_u32 s2, 256
    s_cbranch_scc1 END
KSTART:
    s_getpc_b64 s[76:77]
    s_load_dwordx16 s[40:55], s[0:1], 0
    s_load_dwordx8 s[56:63], s[0:1], 64
    s_load_dwordx4 s[64:67], s[0:1], 96
    v_and_b32 v1, 63, v0
    v_lshrrev_b32 v2, 6, v0
    s_nop 0
    v_readfirstlane_b32 s3, v2
    v_and_b32 v2, 3, v2
    v_lshlrev_b32 v3, 6, v0
    v_min_u32 v3, KEND-KSTART-8, v3
    s_cmp_ge_u32 s3, 7
    s_cbranch_scc1 NOPF
    global_load_dword v31, v3, s[76:77]
NOPF:
    v_mov_b32 v6, 0
    v_mov_b32 v7, 0
    v_lshlrev_b32 v5, 3, v2
    v_add_u32 v5, 163584, v5
    ds_write_b64 v5, v[6:7]
    s_and_b32 s30, s2, 7
    s_lshr_b32 s31, s2, 3
    s_and_b32 s24, s30, 1
    s_lshl_b32 s24, s24, 2
    s_and_b32 s32, s31, 3
    s_add_u32 s24, s24, s32
    s_lshr_b32 s25, s30, 1
    s_mul_i32 s25, s25, 7
    s_lshr_b32 s27, s31, 2
    s_add_u32 s25, s25, s27
    s_lshl_b32 s26, s30, 2
    s_add_u32 s26, s26, s32
    s_cmp_lt_u32 s2, 224
    s_cselect_b32 s28, 1, 0
    s_and_b32 s29, s3, 3
    s_lshl_b32 s77, s30, 5
    s_add_u32 s77, s77, s31
    s_cmp_ge_u32 s3, 4
    s_cbranch_scc1 ROLE_B
    v_lshrrev_b32 v28, 1, v2
    v_lshlrev_b32 v29, 1, v28
    s_lshl_b32 s36, s77, 2
    v_add_u32 v29, s36, v29
    v_lshlrev_b32 v4, 1, v0
    s_lshl_b32 s36, s77, 9
    v_add_u32 v4, s36, v4
    v_xor_b32 v5, 128, v4
    s_waitcnt lgkmcnt(0)
    global_load_ushort v40, v4, s[42:43]
    global_load_ushort v41, v4, s[44:45]
    global_load_ushort v42, v4, s[46:47]
    global_load_ushort v43, v4, s[48:49]
    global_load_ushort v44, v5, s[46:47]
    global_load_ushort v45, v5, s[48:49]
    global_load_ushort v46, v29, s[50:51]
    global_load_ushort v30, v29, s[52:53]
    s_barrier
    s_branch ROLE_A
ROLE_B:
    s_cmp_lg_u32 s3, 7
    s_cbranch_scc1 B_NOX
    v_lshrrev_b32 v25, 3, v1
    v_lshlrev_b32 v25, 10, v25
    v_and_b32 v16, 7, v1
    v_lshl_add_u32 v25, v16, 4, v25
    s_lshl_b32 s31, s2, 13
    v_add_u32 v25, s31, v25
    s_waitcnt lgkmcnt(0)
    global_load_dwordx4 v[128:131], v25, s[40:41] offset:0
    global_load_dwordx4 v[132:135], v25, s[40:41] offset:128
    global_load_dwordx4 v[136:139], v25, s[40:41] offset:256
    global_load_dwordx4 v[140:143], v25, s[40:41] offset:384
    global_load_dwordx4 v[144:147], v25, s[40:41] offset:512
    global_load_dwordx4 v[148:151], v25, s[40:41] offset:640
    global_load_dwordx4 v[152:155], v25, s[40:41] offset:768
    global_load_dwordx4 v[156:159], v25, s[40:41] offset:896
B_NOX:
    v_lshrrev_b32 v12, 3, v1
    v_and_b32 v16, 7, v1
    v_lshrrev_b32 v17, 4, v1
    v_lshrrev_b32 v3, 1, v2
    v_and_b32 v19, 1, v2
    s_lshr_b32 s37, s2, 3
    s_and_b32 s37, s37, 3
    s_lshl_b32 s37, s37, 1
    s_add_u32 s37, s37, s27
    s_and_b32 s37, s37, 7
    s_lshl_b32 s36, s29, 14
    s_mov_b32 s15, 0x00020000
    s_mov_b32 s23, 0x00020000
    s_cmp_eq_u32 s29, 2
    s_cbranch_scc1 B_WOFF
    v_xor_b32 v17, v16, v17
    v_lshlrev_b32 v12, 10, v12
    v_lshl_add_u32 v4, v17, 4, v12
    v_xor_b32 v18, 64, v4
    v_add_u32 v5, 7168, v18
    v_add_u32 v6, 14336, v4
    v_add_u32 v7, 21504, v18
    v_mov_b32 v8, v4
    v_mov_b32 v9, v5
    v_mov_b32 v10, v6
    v_mov_b32 v11, v7
    s_lshl_b32 s32, s24, 18
    s_lshl_b32 s31, s29, 17
    s_add_u32 s32, s32, s31
    s_lshl_b32 s31, s37, 7
    s_add_u32 s32, s32, s31
    s_add_u32 s33, s32, 32768
    s_add_u32 s34, s32, 65536
    s_add_u32 s35, s32, 98304
    s_mov_b32 s68, 128
    s_mov_b32 s69, 4294966400
    s_lshl_b32 s14, s28, 21
    s_lshl_b32 s22, s28, 21
    s_waitcnt lgkmcnt(0)
    s_mov_b32 s12, s40
    s_mov_b32 s13, s41
    s_mov_b32 s20, s40
    s_mov_b32 s21, s41
    s_branch B_OFFD
B_WOFF:
    v_and_b32 v17, 1, v17
    v_lshlrev_b32 v17, 1, v17
    v_xor_b32 v17, v16, v17
    v_mul_u32_u24 v12, 3584, v12
    v_lshl_add_u32 v4, v17, 4, v12
    v_xor_b32 v17, 4, v17
    v_lshl_add_u32 v8, v17, 4, v12
    v_add_u32 v5, 27648, v4
    v_add_u32 v9, 27648, v8
    v_add_u32 v6, 55296, v4
    v_add_u32 v10, 55296, v8
    v_add_u32 v7, 82944, v4
    v_add_u32 v11, 82944, v8
    s_lshl_b32 s32, s25, 7
    s_mul_i32 s31, s37, 229376
    s_add_u32 s32, s32, s31
    s_add_u32 s33, s32, 114688
    s_mov_b32 s34, s32
    s_mov_b32 s35, s33
    s_mov_b32 s68, 229376
    s_mov_b32 s69, 4293361664
    s_mul_i32 s14, s28, 0x1c0000
    s_mul_i32 s22, s28, 0x1c0000
    s_waitcnt lgkmcnt(0)
    s_mov_b32 s12, s56
    s_mov_b32 s13, s57
    s_mov_b32 s20, s58
    s_mov_b32 s21, s59
B_OFFD:
    s_barrier
    s_mov_b32 s8, s66
    s_mov_b32 s9, s67
    s_mov_b32 s10, 0x1000000
    s_mov_b32 s11, 0x00020000
    s_mov_b32 s16, s60
    s_mov_b32 s17, s61
    s_mov_b32 s18, 0x1c0000
    s_mov_b32 s19, 0x00020000
    s_mov_b32 s38, 0xffff0000
    v_mov_b32 v54, 0
    s_cmp_eq_u32 s29, 3
    s_cbranch_scc1 B_LN
    s_cmp_eq_u32 s28, 1
    s_cbranch_scc1 B_LOAD
    v_lshlrev_b32 v25, 10, v1
    s_lshr_b32 s31, s2, 3
    s_sub_u32 s31, s31, 28
    s_mul_i32 s31, s31, 458752
    s_lshl_b32 s30, s29, 17
    s_add_u32 s31, s31, s30
    buffer_load_dword v236, v25, s[16:19], s31 offen offset:384
    s_add_u32 s31, s31, 65536
    buffer_load_dword v236, v25, s[16:19], s31 offen offset:384
    s_add_u32 s31, s31, 65536
B_LOAD:
    s_add_u32 m0, s36, 0
    s_nop 0
    buffer_load_dwordx4 v4, s[12:15], s32 offen offset:0 lds
    buffer_load_dwordx4 v5, s[12:15], s32 offen offset:1024 lds
    buffer_load_dwordx4 v6, s[12:15], s32 offen offset:2048 lds
    buffer_load_dwordx4 v7, s[12:15], s32 offen offset:3072 lds
    s_add_u32 m0, s36, 4096
    s_nop 0
    buffer_load_dwordx4 v4, s[12:15], s33 offen offset:0 lds
    buffer_load_dwordx4 v5, s[12:15], s33 offen offset:1024 lds
    buffer_load_dwordx4 v6, s[12:15], s33 offen offset:2048 lds
    buffer_load_dwordx4 v7, s[12:15], s33 offen offset:3072 lds
    s_add_u32 m0, s36, 8192
    s_nop 0
    buffer_load_dwordx4 v8, s[20:23], s34 offen offset:0 lds
    buffer_load_dwordx4 v9, s[20:23], s34 offen offset:1024 lds
    buffer_load_dwordx4 v10, s[20:23], s34 offen offset:2048 lds
    buffer_load_dwordx4 v11, s[20:23], s34 offen offset:3072 lds
    s_add_u32 m0, s36, 12288
    s_nop 0
    buffer_load_dwordx4 v8, s[20:23], s35 offen offset:0 lds
    buffer_load_dwordx4 v9, s[20:23], s35 offen offset:1024 lds
    buffer_load_dwordx4 v10, s[20:23], s35 offen offset:2048 lds
    buffer_load_dwordx4 v11, s[20:23], s35 offen offset:3072 lds
    s_add_u32 s37, s37, 1
    s_cmp_eq_u32 s37, 8
    s_cselect_b32 s37, 0, s37
    s_cselect_b32 s31, s69, s68
    s_add_u32 s32, s32, s31
    s_add_u32 s33, s33, s31
    s_add_u32 s34, s34, s31
    s_add_u32 s35, s35, s31
    s_add_u32 s36, s36, 49152
    s_cmp_ge_u32 s36, 147456
    s_cselect_b32 s31, 147456, 0
    s_sub_u32 s36, s36, s31
    s_add_u32 m0, s36, 0
    s_nop 0
    buffer_load_dwordx4 v4, s[12:15], s32 offen offset:0 lds
    buffer_load_dwordx4 v5, s[12:15], s32 offen offset:1024 lds
    buffer_load_dwordx4 v6, s[12:15], s32 offen offset:2048 lds
    buffer_load_dwordx4 v7, s[12:15], s32 offen offset:3072 lds
    s_add_u32 m0, s36, 4096
    s_nop 0
    buffer_load_dwordx4 v4, s[12:15], s33 offen offset:0 lds
    buffer_load_dwordx4 v5, s[12:15], s33 offen offset:1024 lds
    buffer_load_dwordx4 v6, s[12:15], s33 offen offset:2048 lds
    buffer_load_dwordx4 v7, s[12:15], s33 offen offset:3072 lds
    s_add_u32 m0, s36, 8192
    s_nop 0
    buffer_load_dwordx4 v8, s[20:23], s34 offen offset:0 lds
    buffer_load_dwordx4 v9, s[20:23], s34 offen offset:1024 lds
    buffer_load_dwordx4 v10, s[20:23], s34 offen offset:2048 lds
    buffer_load_dwordx4 v11, s[20:23], s34 offen offset:3072 lds
    s_add_u32 m0, s36, 12288
    s_nop 0
    buffer_load_dwordx4 v8, s[20:23], s35 offen offset:0 lds
    buffer_load_dwordx4 v9, s[20:23], s35 offen offset:1024 lds
    buffer_load_dwordx4 v10, s[20:23], s35 offen offset:2048 lds
    buffer_load_dwordx4 v11, s[20:23], s35 offen offset:3072 lds
    s_add_u32 s37, s37, 1
    s_cmp_eq_u32 s37, 8
    s_cselect_b32 s37, 0, s37
    s_cselect_b32 s31, s69, s68
    s_add_u32 s32, s32, s31
    s_add_u32 s33, s33, s31
    s_add_u32 s34, s34, s31
    s_add_u32 s35, s35, s31
    s_add_u32 s36, s36, 49152
    s_cmp_ge_u32 s36, 147456
    s_cselect_b32 s31, 147456, 0
    s_sub_u32 s36, s36, s31
    s_branch B_JOIN
B_LN:
    s_mov_b32 s30, 0x3f803f80
    v_mov_b32 v160, 0
    v_mov_b32 v166, 0
    v_mov_b32 v161, 0
    v_mov_b32 v167, 0
    v_mov_b32 v162, 0
    v_mov_b32 v168, 0
    v_mov_b32 v163, 0
    v_mov_b32 v169, 0
    v_lshrrev_b32 v180, 3, v1
    v_and_b32 v181, 7, v1
    v_mul_u32_u24 v182, 1088, v180
    v_lshl_add_u32 v182, v181, 4, v182
    v_add_u32 v182, 153600, v182
    v_bfe_u32 v183, v1, 2, 2
    v_mul_u32_u24 v183, 1088, v183
    v_lshrrev_b32 v184, 4, v1
    v_lshl_add_u32 v183, v184, 5, v183
    v_and_b32 v184, 3, v1
    v_lshl_add_u32 v183, v184, 3, v183
    v_add_u32 v183, 153600, v183
    s_waitcnt vmcnt(7)
    v_dot2_f32_bf16 v160, v128, s30, v160
    v_dot2_f32_bf16 v161, v129, s30, v161
    v_dot2_f32_bf16 v162, v130, s30, v162
    v_dot2_f32_bf16 v163, v131, s30, v163
    s_waitcnt vmcnt(6)
    v_dot2_f32_bf16 v160, v132, s30, v160
    v_dot2_f32_bf16 v161, v133, s30, v161
    v_dot2_f32_bf16 v162, v134, s30, v162
    v_dot2_f32_bf16 v163, v135, s30, v163
    s_waitcnt vmcnt(5)
    v_dot2_f32_bf16 v160, v136, s30, v160
    v_dot2_f32_bf16 v161, v137, s30, v161
    v_dot2_f32_bf16 v162, v138, s30, v162
    v_dot2_f32_bf16 v163, v139, s30, v163
    s_waitcnt vmcnt(4)
    v_dot2_f32_bf16 v160, v140, s30, v160
    v_dot2_f32_bf16 v161, v141, s30, v161
    v_dot2_f32_bf16 v162, v142, s30, v162
    v_dot2_f32_bf16 v163, v143, s30, v163
    s_waitcnt vmcnt(3)
    v_dot2_f32_bf16 v160, v144, s30, v160
    v_dot2_f32_bf16 v161, v145, s30, v161
    v_dot2_f32_bf16 v162, v146, s30, v162
    v_dot2_f32_bf16 v163, v147, s30, v163
    s_waitcnt vmcnt(2)
    v_dot2_f32_bf16 v160, v148, s30, v160
    v_dot2_f32_bf16 v161, v149, s30, v161
    v_dot2_f32_bf16 v162, v150, s30, v162
    v_dot2_f32_bf16 v163, v151, s30, v163
    s_waitcnt vmcnt(1)
    v_dot2_f32_bf16 v160, v152, s30, v160
    v_dot2_f32_bf16 v161, v153, s30, v161
    v_dot2_f32_bf16 v162, v154, s30, v162
    v_dot2_f32_bf16 v163, v155, s30, v163
    s_waitcnt vmcnt(0)
    v_dot2_f32_bf16 v160, v156, s30, v160
    v_dot2_f32_bf16 v161, v157, s30, v161
    v_dot2_f32_bf16 v162, v158, s30, v162
    v_dot2_f32_bf16 v163, v159, s30, v163
    s_nop 0
    v_add_f32 v160, v160, v161
    s_nop 0
    v_add_f32 v162, v162, v163
    v_add_f32 v160, v160, v162
    s_nop 1
    v_add_f32_dpp v160, v160, v160 quad_perm:[1,0,3,2] row_mask:0xf bank_mask:0xf
    s_nop 1
    v_add_f32_dpp v160, v160, v160 quad_perm:[2,3,0,1] row_mask:0xf bank_mask:0xf
    s_nop 1
    v_add_f32_dpp v160, v160, v160 row_half_mirror row_mask:0xf bank_mask:0xf
    v_mul_f32 v160, 0x3b000000, v160
    v_cvt_pk_bf16_f32 v164, v160, v160
    v_lshlrev_b32 v164, 16, v164
    v_lshlrev_b32 v172, 16, v128
    v_and_b32 v173, s38, v128
    v_lshlrev_b32 v174, 16, v129
    v_and_b32 v175, s38, v129
    v_lshlrev_b32 v176, 16, v130
    v_and_b32 v177, s38, v130
    v_lshlrev_b32 v178, 16, v131
    v_and_b32 v179, s38, v131
    v_pk_add_f32 v[172:173], v[172:173], v[164:165] op_sel_hi:[1,0] neg_lo:[0,1] neg_hi:[0,1]
    v_pk_add_f32 v[174:175], v[174:175], v[164:165] op_sel_hi:[1,0] neg_lo:[0,1] neg_hi:[0,1]
    v_pk_add_f32 v[176:177], v[176:177], v[164:165] op_sel_hi:[1,0] neg_lo:[0,1] neg_hi:[0,1]
    v_pk_add_f32 v[178:179], v[178:179], v[164:165] op_sel_hi:[1,0] neg_lo:[0,1] neg_hi:[0,1]
    v_pk_fma_f32 v[166:167], v[172:173], v[172:173], v[166:167]
    v_cvt_pk_bf16_f32 v128, v172, v173
    v_pk_fma_f32 v[168:169], v[174:175], v[174:175], v[168:169]
    v_cvt_pk_bf16_f32 v129, v174, v175
    v_pk_fma_f32 v[166:167], v[176:177], v[176:177], v[166:167]
    v_cvt_pk_bf16_f32 v130, v176, v177
    v_pk_fma_f32 v[168:169], v[178:179], v[178:179], v[168:169]
    v_cvt_pk_bf16_f32 v131, v178, v179
    v_lshlrev_b32 v172, 16, v132
    v_and_b32 v173, s38, v132
    v_lshlrev_b32 v174, 16, v133
    v_and_b32 v175, s38, v133
    v_lshlrev_b32 v176, 16, v134
    v_and_b32 v177, s38, v134
    v_lshlrev_b32 v178, 16, v135
    v_and_b32 v179, s38, v135
    v_pk_add_f32 v[172:173], v[172:173], v[164:165] op_sel_hi:[1,0] neg_lo:[0,1] neg_hi:[0,1]
    v_pk_add_f32 v[174:175], v[174:175], v[164:165] op_sel_hi:[1,0] neg_lo:[0,1] neg_hi:[0,1]
    v_pk_add_f32 v[176:177], v[176:177], v[164:165] op_sel_hi:[1,0] neg_lo:[0,1] neg_hi:[0,1]
    v_pk_add_f32 v[178:179], v[178:179], v[164:165] op_sel_hi:[1,0] neg_lo:[0,1] neg_hi:[0,1]
    v_pk_fma_f32 v[166:167], v[172:173], v[172:173], v[166:167]
    v_cvt_pk_bf16_f32 v132, v172, v173
    v_pk_fma_f32 v[168:169], v[174:175], v[174:175], v[168:169]
    v_cvt_pk_bf16_f32 v133, v174, v175
    v_pk_fma_f32 v[166:167], v[176:177], v[176:177], v[166:167]
    v_cvt_pk_bf16_f32 v134, v176, v177
    v_pk_fma_f32 v[168:169], v[178:179], v[178:179], v[168:169]
    v_cvt_pk_bf16_f32 v135, v178, v179
    v_lshlrev_b32 v172, 16, v136
    v_and_b32 v173, s38, v136
    v_lshlrev_b32 v174, 16, v137
    v_and_b32 v175, s38, v137
    v_lshlrev_b32 v176, 16, v138
    v_and_b32 v177, s38, v138
    v_lshlrev_b32 v178, 16, v139
    v_and_b32 v179, s38, v139
    v_pk_add_f32 v[172:173], v[172:173], v[164:165] op_sel_hi:[1,0] neg_lo:[0,1] neg_hi:[0,1]
    v_pk_add_f32 v[174:175], v[174:175], v[164:165] op_sel_hi:[1,0] neg_lo:[0,1] neg_hi:[0,1]
    v_pk_add_f32 v[176:177], v[176:177], v[164:165] op_sel_hi:[1,0] neg_lo:[0,1] neg_hi:[0,1]
    v_pk_add_f32 v[178:179], v[178:179], v[164:165] op_sel_hi:[1,0] neg_lo:[0,1] neg_hi:[0,1]
    v_pk_fma_f32 v[166:167], v[172:173], v[172:173], v[166:167]
    v_cvt_pk_bf16_f32 v136, v172, v173
    v_pk_fma_f32 v[168:169], v[174:175], v[174:175], v[168:169]
    v_cvt_pk_bf16_f32 v137, v174, v175
    v_pk_fma_f32 v[166:167], v[176:177], v[176:177], v[166:167]
    v_cvt_pk_bf16_f32 v138, v176, v177
    v_pk_fma_f32 v[168:169], v[178:179], v[178:179], v[168:169]
    v_cvt_pk_bf16_f32 v139, v178, v179
    v_lshlrev_b32 v172, 16, v140
    v_and_b32 v173, s38, v140
    v_lshlrev_b32 v174, 16, v141
    v_and_b32 v175, s38, v141
    v_lshlrev_b32 v176, 16, v142
    v_and_b32 v177, s38, v142
    v_lshlrev_b32 v178, 16, v143
    v_and_b32 v179, s38, v143
    v_pk_add_f32 v[172:173], v[172:173], v[164:165] op_sel_hi:[1,0] neg_lo:[0,1] neg_hi:[0,1]
    v_pk_add_f32 v[174:175], v[174:175], v[164:165] op_sel_hi:[1,0] neg_lo:[0,1] neg_hi:[0,1]
    v_pk_add_f32 v[176:177], v[176:177], v[164:165] op_sel_hi:[1,0] neg_lo:[0,1] neg_hi:[0,1]
    v_pk_add_f32 v[178:179], v[178:179], v[164:165] op_sel_hi:[1,0] neg_lo:[0,1] neg_hi:[0,1]
    v_pk_fma_f32 v[166:167], v[172:173], v[172:173], v[166:167]
    v_cvt_pk_bf16_f32 v140, v172, v173
    v_pk_fma_f32 v[168:169], v[174:175], v[174:175], v[168:169]
    v_cvt_pk_bf16_f32 v141, v174, v175
    v_pk_fma_f32 v[166:167], v[176:177], v[176:177], v[166:167]
    v_cvt_pk_bf16_f32 v142, v176, v177
    v_pk_fma_f32 v[168:169], v[178:179], v[178:179], v[168:169]
    v_cvt_pk_bf16_f32 v143, v178, v179
    v_lshlrev_b32 v172, 16, v144
    v_and_b32 v173, s38, v144
    v_lshlrev_b32 v174, 16, v145
    v_and_b32 v175, s38, v145
    v_lshlrev_b32 v176, 16, v146
    v_and_b32 v177, s38, v146
    v_lshlrev_b32 v178, 16, v147
    v_and_b32 v179, s38, v147
    v_pk_add_f32 v[172:173], v[172:173], v[164:165] op_sel_hi:[1,0] neg_lo:[0,1] neg_hi:[0,1]
    v_pk_add_f32 v[174:175], v[174:175], v[164:165] op_sel_hi:[1,0] neg_lo:[0,1] neg_hi:[0,1]
    v_pk_add_f32 v[176:177], v[176:177], v[164:165] op_sel_hi:[1,0] neg_lo:[0,1] neg_hi:[0,1]
    v_pk_add_f32 v[178:179], v[178:179], v[164:165] op_sel_hi:[1,0] neg_lo:[0,1] neg_hi:[0,1]
    v_pk_fma_f32 v[166:167], v[172:173], v[172:173], v[166:167]
    v_cvt_pk_bf16_f32 v144, v172, v173
    v_pk_fma_f32 v[168:169], v[174:175], v[174:175], v[168:169]
    v_cvt_pk_bf16_f32 v145, v174, v175
    v_pk_fma_f32 v[166:167], v[176:177], v[176:177], v[166:167]
    v_cvt_pk_bf16_f32 v146, v176, v177
    v_pk_fma_f32 v[168:169], v[178:179], v[178:179], v[168:169]
    v_cvt_pk_bf16_f32 v147, v178, v179
    v_lshlrev_b32 v172, 16, v148
    v_and_b32 v173, s38, v148
    v_lshlrev_b32 v174, 16, v149
    v_and_b32 v175, s38, v149
    v_lshlrev_b32 v176, 16, v150
    v_and_b32 v177, s38, v150
    v_lshlrev_b32 v178, 16, v151
    v_and_b32 v179, s38, v151
    v_pk_add_f32 v[172:173], v[172:173], v[164:165] op_sel_hi:[1,0] neg_lo:[0,1] neg_hi:[0,1]
    v_pk_add_f32 v[174:175], v[174:175], v[164:165] op_sel_hi:[1,0] neg_lo:[0,1] neg_hi:[0,1]
    v_pk_add_f32 v[176:177], v[176:177], v[164:165] op_sel_hi:[1,0] neg_lo:[0,1] neg_hi:[0,1]
    v_pk_add_f32 v[178:179], v[178:179], v[164:165] op_sel_hi:[1,0] neg_lo:[0,1] neg_hi:[0,1]
    v_pk_fma_f32 v[166:167], v[172:173], v[172:173], v[166:167]
    v_cvt_pk_bf16_f32 v148, v172, v173
    v_pk_fma_f32 v[168:169], v[174:175], v[174:175], v[168:169]
    v_cvt_pk_bf16_f32 v149, v174, v175
    v_pk_fma_f32 v[166:167], v[176:177], v[176:177], v[166:167]
    v_cvt_pk_bf16_f32 v150, v176, v177
    v_pk_fma_f32 v[168:169], v[178:179], v[178:179], v[168:169]
    v_cvt_pk_bf16_f32 v151, v178, v179
    v_lshlrev_b32 v172, 16, v152
    v_and_b32 v173, s38, v152
    v_lshlrev_b32 v174, 16, v153
    v_and_b32 v175, s38, v153
    v_lshlrev_b32 v176, 16, v154
    v_and_b32 v177, s38, v154
    v_lshlrev_b32 v178, 16, v155
    v_and_b32 v179, s38, v155
    v_pk_add_f32 v[172:173], v[172:173], v[164:165] op_sel_hi:[1,0] neg_lo:[0,1] neg_hi:[0,1]
    v_pk_add_f32 v[174:175], v[174:175], v[164:165] op_sel_hi:[1,0] neg_lo:[0,1] neg_hi:[0,1]
    v_pk_add_f32 v[176:177], v[176:177], v[164:165] op_sel_hi:[1,0] neg_lo:[0,1] neg_hi:[0,1]
    v_pk_add_f32 v[178:179], v[178:179], v[164:165] op_sel_hi:[1,0] neg_lo:[0,1] neg_hi:[0,1]
    v_pk_fma_f32 v[166:167], v[172:173], v[172:173], v[166:167]
    v_cvt_pk_bf16_f32 v152, v172, v173
    v_pk_fma_f32 v[168:169], v[174:175], v[174:175], v[168:169]
    v_cvt_pk_bf16_f32 v153, v174, v175
    v_pk_fma_f32 v[166:167], v[176:177], v[176:177], v[166:167]
    v_cvt_pk_bf16_f32 v154, v176, v177
    v_pk_fma_f32 v[168:169], v[178:179], v[178:179], v[168:169]
    v_cvt_pk_bf16_f32 v155, v178, v179
    v_lshlrev_b32 v172, 16, v156
    v_and_b32 v173, s38, v156
    v_lshlrev_b32 v174, 16, v157
    v_and_b32 v175, s38, v157
    v_lshlrev_b32 v176, 16, v158
    v_and_b32 v177, s38, v158
    v_lshlrev_b32 v178, 16, v159
    v_and_b32 v179, s38, v159
    v_pk_add_f32 v[172:173], v[172:173], v[164:165] op_sel_hi:[1,0] neg_lo:[0,1] neg_hi:[0,1]
    v_pk_add_f32 v[174:175], v[174:175], v[164:165] op_sel_hi:[1,0] neg_lo:[0,1] neg_hi:[0,1]
    v_pk_add_f32 v[176:177], v[176:177], v[164:165] op_sel_hi:[1,0] neg_lo:[0,1] neg_hi:[0,1]
    v_pk_add_f32 v[178:179], v[178:179], v[164:165] op_sel_hi:[1,0] neg_lo:[0,1] neg_hi:[0,1]
    v_pk_fma_f32 v[166:167], v[172:173], v[172:173], v[166:167]
    v_cvt_pk_bf16_f32 v156, v172, v173
    v_pk_fma_f32 v[168:169], v[174:175], v[174:175], v[168:169]
    v_cvt_pk_bf16_f32 v157, v174, v175
    v_pk_fma_f32 v[166:167], v[176:177], v[176:177], v[166:167]
    v_cvt_pk_bf16_f32 v158, v176, v177
    v_pk_fma_f32 v[168:169], v[178:179], v[178:179], v[168:169]
    v_cvt_pk_bf16_f32 v159, v178, v179
    v_add_f32 v166, v166, v167
    v_add_f32 v168, v168, v169
    v_add_f32 v166, v166, v168
    s_nop 1
    v_add_f32_dpp v166, v166, v166 quad_perm:[1,0,3,2] row_mask:0xf bank_mask:0xf
    s_nop 1
    v_add_f32_dpp v166, v166, v166 quad_perm:[2,3,0,1] row_mask:0xf bank_mask:0xf
    s_nop 1
    v_add_f32_dpp v166, v166, v166 row_half_mirror row_mask:0xf bank_mask:0xf
    v_sub_f32 v161, v160, v164
    v_mul_f32 v161, v161, v161
    v_mul_f32 v166, 0x3b000000, v166
    v_sub_f32 v166, v166, v161
    v_max_f32 v166, 0, v166
    v_cvt_pk_bf16_f32 v166, v166, v166
    v_lshlrev_b32 v166, 16, v166
    v_add_f32 v166, 0x3727c5ac, v166
    v_cvt_pk_bf16_f32 v166, v166, v166
    v_lshlrev_b32 v166, 16, v166
    v_sqrt_f32 v166, v166
    s_nop 0
    v_cvt_pk_bf16_f32 v166, v166, v166
    v_lshlrev_b32 v166, 16, v166
    v_rcp_f32 v165, v166
    v_lshlrev_b32 v172, 16, v128
    v_and_b32 v173, s38, v128
    v_lshlrev_b32 v174, 16, v129
    v_and_b32 v175, s38, v129
    v_lshlrev_b32 v176, 16, v130
    v_and_b32 v177, s38, v130
    v_lshlrev_b32 v178, 16, v131
    v_and_b32 v179, s38, v131
    v_pk_mul_f32 v[172:173], v[164:165], v[172:173] op_sel:[1,0] op_sel_hi:[1,1]
    v_pk_mul_f32 v[174:175], v[164:165], v[174:175] op_sel:[1,0] op_sel_hi:[1,1]
    v_pk_mul_f32 v[176:177], v[164:165], v[176:177] op_sel:[1,0] op_sel_hi:[1,1]
    v_pk_mul_f32 v[178:179], v[164:165], v[178:179] op_sel:[1,0] op_sel_hi:[1,1]
    v_cvt_pk_bf16_f32 v128, v172, v173
    v_cvt_pk_bf16_f32 v129, v174, v175
    v_cvt_pk_bf16_f32 v130, v176, v177
    v_cvt_pk_bf16_f32 v131, v178, v179
    ds_write_b128 v182, v[128:131] offset:0
    v_lshlrev_b32 v172, 16, v132
    v_and_b32 v173, s38, v132
    v_lshlrev_b32 v174, 16, v133
    v_and_b32 v175, s38, v133
    v_lshlrev_b32 v176, 16, v134
    v_and_b32 v177, s38, v134
    v_lshlrev_b32 v178, 16, v135
    v_and_b32 v179, s38, v135
    v_pk_mul_f32 v[172:173], v[164:165], v[172:173] op_sel:[1,0] op_sel_hi:[1,1]
    v_pk_mul_f32 v[174:175], v[164:165], v[174:175] op_sel:[1,0] op_sel_hi:[1,1]
    v_pk_mul_f32 v[176:177], v[164:165], v[176:177] op_sel:[1,0] op_sel_hi:[1,1]
    v_pk_mul_f32 v[178:179], v[164:165], v[178:179] op_sel:[1,0] op_sel_hi:[1,1]
    v_cvt_pk_bf16_f32 v132, v172, v173
    v_cvt_pk_bf16_f32 v133, v174, v175
    v_cvt_pk_bf16_f32 v134, v176, v177
    v_cvt_pk_bf16_f32 v135, v178, v179
    ds_write_b128 v182, v[132:135] offset:128
    v_lshlrev_b32 v172, 16, v136
    v_and_b32 v173, s38, v136
    v_lshlrev_b32 v174, 16, v137
    v_and_b32 v175, s38, v137
    v_lshlrev_b32 v176, 16, v138
    v_and_b32 v177, s38, v138
    v_lshlrev_b32 v178, 16, v139
    v_and_b32 v179, s38, v139
    v_pk_mul_f32 v[172:173], v[164:165], v[172:173] op_sel:[1,0] op_sel_hi:[1,1]
    v_pk_mul_f32 v[174:175], v[164:165], v[174:175] op_sel:[1,0] op_sel_hi:[1,1]
    v_pk_mul_f32 v[176:177], v[164:165], v[176:177] op_sel:[1,0] op_sel_hi:[1,1]
    v_pk_mul_f32 v[178:179], v[164:165], v[178:179] op_sel:[1,0] op_sel_hi:[1,1]
    v_cvt_pk_bf16_f32 v136, v172, v173
    v_cvt_pk_bf16_f32 v137, v174, v175
    v_cvt_pk_bf16_f32 v138, v176, v177
    v_cvt_pk_bf16_f32 v139, v178, v179
    ds_write_b128 v182, v[136:139] offset:256
    v_lshlrev_b32 v172, 16, v140
    v_and_b32 v173, s38, v140
    v_lshlrev_b32 v174, 16, v141
    v_and_b32 v175, s38, v141
    v_lshlrev_b32 v176, 16, v142
    v_and_b32 v177, s38, v142
    v_lshlrev_b32 v178, 16, v143
    v_and_b32 v179, s38, v143
    v_pk_mul_f32 v[172:173], v[164:165], v[172:173] op_sel:[1,0] op_sel_hi:[1,1]
    v_pk_mul_f32 v[174:175], v[164:165], v[174:175] op_sel:[1,0] op_sel_hi:[1,1]
    v_pk_mul_f32 v[176:177], v[164:165], v[176:177] op_sel:[1,0] op_sel_hi:[1,1]
    v_pk_mul_f32 v[178:179], v[164:165], v[178:179] op_sel:[1,0] op_sel_hi:[1,1]
    v_cvt_pk_bf16_f32 v140, v172, v173
    v_cvt_pk_bf16_f32 v141, v174, v175
    v_cvt_pk_bf16_f32 v142, v176, v177
    v_cvt_pk_bf16_f32 v143, v178, v179
    ds_write_b128 v182, v[140:143] offset:384
    v_lshlrev_b32 v172, 16, v144
    v_and_b32 v173, s38, v144
    v_lshlrev_b32 v174, 16, v145
    v_and_b32 v175, s38, v145
    v_lshlrev_b32 v176, 16, v146
    v_and_b32 v177, s38, v146
    v_lshlrev_b32 v178, 16, v147
    v_and_b32 v179, s38, v147
    v_pk_mul_f32 v[172:173], v[164:165], v[172:173] op_sel:[1,0] op_sel_hi:[1,1]
    v_pk_mul_f32 v[174:175], v[164:165], v[174:175] op_sel:[1,0] op_sel_hi:[1,1]
    v_pk_mul_f32 v[176:177], v[164:165], v[176:177] op_sel:[1,0] op_sel_hi:[1,1]
    v_pk_mul_f32 v[178:179], v[164:165], v[178:179] op_sel:[1,0] op_sel_hi:[1,1]
    v_cvt_pk_bf16_f32 v144, v172, v173
    v_cvt_pk_bf16_f32 v145, v174, v175
    v_cvt_pk_bf16_f32 v146, v176, v177
    v_cvt_pk_bf16_f32 v147, v178, v179
    ds_write_b128 v182, v[144:147] offset:512
    v_lshlrev_b32 v172, 16, v148
    v_and_b32 v173, s38, v148
    v_lshlrev_b32 v174, 16, v149
    v_and_b32 v175, s38, v149
    v_lshlrev_b32 v176, 16, v150
    v_and_b32 v177, s38, v150
    v_lshlrev_b32 v178, 16, v151
    v_and_b32 v179, s38, v151
    v_pk_mul_f32 v[172:173], v[164:165], v[172:173] op_sel:[1,0] op_sel_hi:[1,1]
    v_pk_mul_f32 v[174:175], v[164:165], v[174:175] op_sel:[1,0] op_sel_hi:[1,1]
    v_pk_mul_f32 v[176:177], v[164:165], v[176:177] op_sel:[1,0] op_sel_hi:[1,1]
    v_pk_mul_f32 v[178:179], v[164:165], v[178:179] op_sel:[1,0] op_sel_hi:[1,1]
    v_cvt_pk_bf16_f32 v148, v172, v173
    v_cvt_pk_bf16_f32 v149, v174, v175
    v_cvt_pk_bf16_f32 v150, v176, v177
    v_cvt_pk_bf16_f32 v151, v178, v179
    ds_write_b128 v182, v[148:151] offset:640
    v_lshlrev_b32 v172, 16, v152
    v_and_b32 v173, s38, v152
    v_lshlrev_b32 v174, 16, v153
    v_and_b32 v175, s38, v153
    v_lshlrev_b32 v176, 16, v154
    v_and_b32 v177, s38, v154
    v_lshlrev_b32 v178, 16, v155
    v_and_b32 v179, s38, v155
    v_pk_mul_f32 v[172:173], v[164:165], v[172:173] op_sel:[1,0] op_sel_hi:[1,1]
    v_pk_mul_f32 v[174:175], v[164:165], v[174:175] op_sel:[1,0] op_sel_hi:[1,1]
    v_pk_mul_f32 v[176:177], v[164:165], v[176:177] op_sel:[1,0] op_sel_hi:[1,1]
    v_pk_mul_f32 v[178:179], v[164:165], v[178:179] op_sel:[1,0] op_sel_hi:[1,1]
    v_cvt_pk_bf16_f32 v152, v172, v173
    v_cvt_pk_bf16_f32 v153, v174, v175
    v_cvt_pk_bf16_f32 v154, v176, v177
    v_cvt_pk_bf16_f32 v155, v178, v179
    ds_write_b128 v182, v[152:155] offset:768
    v_lshlrev_b32 v172, 16, v156
    v_and_b32 v173, s38, v156
    v_lshlrev_b32 v174, 16, v157
    v_and_b32 v175, s38, v157
    v_lshlrev_b32 v176, 16, v158
    v_and_b32 v177, s38, v158
    v_lshlrev_b32 v178, 16, v159
    v_and_b32 v179, s38, v159
    v_pk_mul_f32 v[172:173], v[164:165], v[172:173] op_sel:[1,0] op_sel_hi:[1,1]
    v_pk_mul_f32 v[174:175], v[164:165], v[174:175] op_sel:[1,0] op_sel_hi:[1,1]
    v_pk_mul_f32 v[176:177], v[164:165], v[176:177] op_sel:[1,0] op_sel_hi:[1,1]
    v_pk_mul_f32 v[178:179], v[164:165], v[178:179] op_sel:[1,0] op_sel_hi:[1,1]
    v_cvt_pk_bf16_f32 v156, v172, v173
    v_cvt_pk_bf16_f32 v157, v174, v175
    v_cvt_pk_bf16_f32 v158, v176, v177
    v_cvt_pk_bf16_f32 v159, v178, v179
    ds_write_b128 v182, v[156:159] offset:896
    ds_read_b64_tr_b16 v[128:129], v183 offset:0
    ds_read_b64_tr_b16 v[130:131], v183 offset:4352
    ds_read_b64_tr_b16 v[132:133], v183 offset:128
    ds_read_b64_tr_b16 v[134:135], v183 offset:4480
    ds_read_b64_tr_b16 v[136:137], v183 offset:256
    ds_read_b64_tr_b16 v[138:139], v183 offset:4608
    ds_read_b64_tr_b16 v[140:141], v183 offset:384
    ds_read_b64_tr_b16 v[142:143], v183 offset:4736
    ds_read_b64_tr_b16 v[144:145], v183 offset:512
    ds_read_b64_tr_b16 v[146:147], v183 offset:4864
    ds_read_b64_tr_b16 v[148:149], v183 offset:640
    ds_read_b64_tr_b16 v[150:151], v183 offset:4992
    ds_read_b64_tr_b16 v[152:153], v183 offset:768
    ds_read_b64_tr_b16 v[154:155], v183 offset:5120
    ds_read_b64_tr_b16 v[156:157], v183 offset:896
    ds_read_b64_tr_b16 v[158:159], v183 offset:5248
B_JOIN:
    s_mov_b32 s4, s40
    s_mov_b32 s5, s41
    s_mov_b32 s6, 0x200000
    s_mov_b32 s7, 0x00020000
    v_and_b32 v27, 255, v0
    v_and_b32 v24, 3, v1
    v_lshl_add_u32 v24, v3, 2, v24
    v_bfe_u32 v25, v1, 3, 1
    v_lshl_add_u32 v25, v19, 1, v25
    v_lshlrev_b32 v25, 1, v25
    v_xor_b32 v24, v24, v25
    v_lshlrev_b32 v24, 4, v24
    v_lshrrev_b32 v25, 2, v1
    v_lshl_add_u32 v24, v25, 7, v24
    v_lshl_add_u32 v24, v19, 13, v24
    v_add_u32 v24, 32768, v24
    v_add_u32 v26, 98304, v24
    v_and_b32 v20, 1, v1
    v_lshlrev_b32 v20, 4, v20
    v_mov_b32 v21, 0x3f80
    v_lshlrev_b32 v21, v20, v21
    v_bfe_u32 v22, v1, 1, 2
    v_cmp_eq_u32 vcc, 0, v22
    s_nop 1
    v_cndmask_b32 v16, 0, v21, vcc
    v_cmp_eq_u32 vcc, 1, v22
    s_nop 1
    v_cndmask_b32 v17, 0, v21, vcc
    v_cmp_eq_u32 vcc, 2, v22
    s_nop 1
    v_cndmask_b32 v18, 0, v21, vcc
    v_cmp_eq_u32 vcc, 3, v22
    s_nop 1
    v_cndmask_b32 v19, 0, v21, vcc
    v_mov_b32 v20, 0
    v_mov_b32 v232, 0
    v_mov_b32 v21, 0
    v_mov_b32 v233, 0
    v_mov_b32 v22, 0
    v_mov_b32 v234, 0
    v_mov_b32 v23, 0
    v_mov_b32 v235, 0
    v_lshlrev_b32 v123, 10, v1
    s_lshr_b32 s70, s2, 3
    s_lshl_b32 s70, s70, 16
    s_and_b32 s73, s2, 7
    s_cmp_ge_u32 s73, 6
    s_cselect_b32 s31, 6, 0
    s_sub_u32 s73, s73, s31
    s_cmp_eq_u32 s29, 3
    s_cbranch_scc1 B_NW1
    s_waitcnt vmcnt(16)
B_NW1:
    s_waitcnt lgkmcnt(0)
    s_barrier
    s_setprio 3
    ds_read_b128 v[240:243], v24 offset:0
    ds_read_b128 v[244:247], v24 offset:2048
    ds_read_b128 v[248:251], v24 offset:4096
    ds_read_b128 v[252:255], v24 offset:6144
    s_cmp_eq_u32 s29, 3
    s_cbranch_scc1 B_AUX2
    s_add_u32 m0, s36, 0
    s_nop 0
    buffer_load_dwordx4 v4, s[12:15], s32 offen offset:0 lds
    buffer_load_dwordx4 v5, s[12:15], s32 offen offset:1024 lds
    buffer_load_dwordx4 v6, s[12:15], s32 offen offset:2048 lds
    buffer_load_dwordx4 v7, s[12:15], s32 offen offset:3072 lds
    s_add_u32 m0, s36, 4096
    s_nop 0
    buffer_load_dwordx4 v4, s[12:15], s33 offen offset:0 lds
    buffer_load_dwordx4 v5, s[12:15], s33 offen offset:1024 lds
    buffer_load_dwordx4 v6, s[12:15], s33 offen offset:2048 lds
    buffer_load_dwordx4 v7, s[12:15], s33 offen offset:3072 lds
    s_add_u32 m0, s36, 8192
    s_nop 0
    buffer_load_dwordx4 v8, s[20:23], s34 offen offset:0 lds
    buffer_load_dwordx4 v9, s[20:23], s34 offen offset:1024 lds
    buffer_load_dwordx4 v10, s[20:23], s34 offen offset:2048 lds
    buffer_load_dwordx4 v11, s[20:23], s34 offen offset:3072 lds
    s_add_u32 m0, s36, 12288
    s_nop 0
    buffer_load_dwordx4 v8, s[20:23], s35 offen offset:0 lds
    buffer_load_dwordx4 v9, s[20:23], s35 offen offset:1024 lds
    buffer_load_dwordx4 v10, s[20:23], s35 offen offset:2048 lds
    buffer_load_dwordx4 v11, s[20:23], s35 offen offset:3072 lds
    s_add_u32 s37, s37, 1
    s_cmp_eq_u32 s37, 8
    s_cselect_b32 s37, 0, s37
    s_cselect_b32 s31, s69, s68
    s_add_u32 s32, s32, s31
    s_add_u32 s33, s33, s31
    s_add_u32 s34, s34, s31
    s_add_u32 s35, s35, s31
    s_add_u32 s36, s36, 49152
    s_cmp_ge_u32 s36, 147456
    s_cselect_b32 s31, 147456, 0
    s_sub_u32 s36, s36, s31
    s_branch B_AJ2
B_AUX2:
    v_lshrrev_b32 v180, 3, v1
    v_and_b32 v181, 7, v1
    v_lshlrev_b32 v184, 15, v180
    v_lshl_add_u32 v184, v181, 4, v184
    v_lshlrev_b32 v185, 3, v180
    s_lshl_b32 s31, s2, 6
    v_cmp_eq_u32 vcc, 0, v181
    s_nop 0
    s_and_saveexec_b64 s[74:75], vcc
    buffer_store_dwordx2 v[164:165], v185, s[8:11], s31 offen offset:0 sc1
    s_mov_b64 exec, s[74:75]
    s_lshl_b32 s31, s2, 7
    s_add_u32 s31, s31, 1048576
    buffer_store_dwordx4 v[128:131], v184, s[8:11], s31 offen sc1
    s_add_u32 s31, s31, 262144
    buffer_store_dwordx4 v[132:135], v184, s[8:11], s31 offen sc1
    s_add_u32 s31, s31, 262144
    buffer_store_dwordx4 v[136:139], v184, s[8:11], s31 offen sc1
    s_add_u32 s31, s31, 262144
    buffer_store_dwordx4 v[140:143], v184, s[8:11], s31 offen sc1
    s_add_u32 s31, s31, 262144
    buffer_store_dwordx4 v[144:147], v184, s[8:11], s31 offen sc1
    s_add_u32 s31, s31, 262144
    buffer_store_dwordx4 v[148:151], v184, s[8:11], s31 offen sc1
    s_add_u32 s31, s31, 262144
    buffer_store_dwordx4 v[152:155], v184, s[8:11], s31 offen sc1
    s_add_u32 s31, s31, 262144
    buffer_store_dwordx4 v[156:159], v184, s[8:11], s31 offen sc1
    s_add_u32 s31, s31, 262144
    global_load_dword v126, v54, s[64:65] sc1
B_AJ2:
    s_waitcnt lgkmcnt(0)
    v_mfma_f32_16x16x32_bf16 v[20:23], v[16:19], v[240:243], v[20:23]
    v_mfma_f32_16x16x32_bf16 v[20:23], v[16:19], v[244:247], v[20:23]
    v_mfma_f32_16x16x32_bf16 v[20:23], v[16:19], v[248:251], v[20:23]
    v_mfma_f32_16x16x32_bf16 v[20:23], v[16:19], v[252:255], v[20:23]
    s_cmp_eq_u32 s29, 3
    s_cbranch_scc1 B_NW3
    s_waitcnt vmcnt(16)
B_NW3:
    s_waitcnt lgkmcnt(0)
    s_barrier
    ds_read_b128 v[240:243], v24 offset:49152
    ds_read_b128 v[244:247], v24 offset:51200
    ds_read_b128 v[248:251], v24 offset:53248
    ds_read_b128 v[252:255], v24 offset:55296
    s_cmp_eq_u32 s29, 3
    s_cbranch_scc1 B_AUX4
    s_add_u32 m0, s36, 0
    s_nop 0
    buffer_load_dwordx4 v4, s[12:15], s32 offen offset:0 lds
    buffer_load_dwordx4 v5, s[12:15], s32 offen offset:1024 lds
    buffer_load_dwordx4 v6, s[12:15], s32 offen offset:2048 lds
    buffer_load_dwordx4 v7, s[12:15], s32 offen offset:3072 lds
    s_add_u32 m0, s36, 4096
    s_nop 0
    buffer_load_dwordx4 v4, s[12:15], s33 offen offset:0 lds
    buffer_load_dwordx4 v5, s[12:15], s33 offen offset:1024 lds
    buffer_load_dwordx4 v6, s[12:15], s33 offen offset:2048 lds
    buffer_load_dwordx4 v7, s[12:15], s33 offen offset:3072 lds
    s_add_u32 m0, s36, 8192
    s_nop 0
    buffer_load_dwordx4 v8, s[20:23], s34 offen offset:0 lds
    buffer_load_dwordx4 v9, s[20:23], s34 offen offset:1024 lds
    buffer_load_dwordx4 v10, s[20:23], s34 offen offset:2048 lds
    buffer_load_dwordx4 v11, s[20:23], s34 offen offset:3072 lds
    s_add_u32 m0, s36, 12288
    s_nop 0
    buffer_load_dwordx4 v8, s[20:23], s35 offen offset:0 lds
    buffer_load_dwordx4 v9, s[20:23], s35 offen offset:1024 lds
    buffer_load_dwordx4 v10, s[20:23], s35 offen offset:2048 lds
    buffer_load_dwordx4 v11, s[20:23], s35 offen offset:3072 lds
    s_add_u32 s37, s37, 1
    s_cmp_eq_u32 s37, 8
    s_cselect_b32 s37, 0, s37
    s_cselect_b32 s31, s69, s68
    s_add_u32 s32, s32, s31
    s_add_u32 s33, s33, s31
    s_add_u32 s34, s34, s31
    s_add_u32 s35, s35, s31
    s_add_u32 s36, s36, 49152
    s_cmp_ge_u32 s36, 147456
    s_cselect_b32 s31, 147456, 0
    s_sub_u32 s36, s36, s31
    s_branch B_AJ4
B_AUX4:
    buffer_load_dword v236, v123, s[16:19], s70 offen offset:0
    buffer_load_dword v236, v123, s[16:19], s70 offen offset:128
B_AJ4:
    s_waitcnt lgkmcnt(0)
    v_mfma_f32_16x16x32_bf16 v[20:23], v[16:19], v[240:243], v[20:23]
    v_mfma_f32_16x16x32_bf16 v[20:23], v[16:19], v[244:247], v[20:23]
    v_mfma_f32_16x16x32_bf16 v[20:23], v[16:19], v[248:251], v[20:23]
    v_mfma_f32_16x16x32_bf16 v[20:23], v[16:19], v[252:255], v[20:23]
    s_cmp_eq_u32 s29, 3
    s_cbranch_scc1 B_NW5
    s_waitcnt vmcnt(16)
B_NW5:
    s_waitcnt lgkmcnt(0)
    s_barrier
    ds_read_b128 v[240:243], v26 offset:0
    ds_read_b128 v[244:247], v26 offset:2048
    ds_read_b128 v[248:251], v26 offset:4096
    ds_read_b128 v[252:255], v26 offset:6144
    s_cmp_eq_u32 s29, 3
    s_cbranch_scc1 B_AUX6
    s_add_u32 m0, s36, 0
    s_nop 0
    buffer_load_dwordx4 v4, s[12:15], s32 offen offset:0 lds
    buffer_load_dwordx4 v5, s[12:15], s32 offen offset:1024 lds
    buffer_load_dwordx4 v6, s[12:15], s32 offen offset:2048 lds
    buffer_load_dwordx4 v7, s[12:15], s32 offen offset:3072 lds
    s_add_u32 m0, s36, 4096
    s_nop 0
    buffer_load_dwordx4 v4, s[12:15], s33 offen offset:0 lds
    buffer_load_dwordx4 v5, s[12:15], s33 offen offset:1024 lds
    buffer_load_dwordx4 v6, s[12:15], s33 offen offset:2048 lds
    buffer_load_dwordx4 v7, s[12:15], s33 offen offset:3072 lds
    s_add_u32 m0, s36, 8192
    s_nop 0
    buffer_load_dwordx4 v8, s[20:23], s34 offen offset:0 lds
    buffer_load_dwordx4 v9, s[20:23], s34 offen offset:1024 lds
    buffer_load_dwordx4 v10, s[20:23], s34 offen offset:2048 lds
    buffer_load_dwordx4 v11, s[20:23], s34 offen offset:3072 lds
    s_add_u32 m0, s36, 12288
    s_nop 0
    buffer_load_dwordx4 v8, s[20:23], s35 offen offset:0 lds
    buffer_load_dwordx4 v9, s[20:23], s35 offen offset:1024 lds
    buffer_load_dwordx4 v10, s[20:23], s35 offen offset:2048 lds
    buffer_load_dwordx4 v11, s[20:23], s35 offen offset:3072 lds
    s_add_u32 s37, s37, 1
    s_cmp_eq_u32 s37, 8
    s_cselect_b32 s37, 0, s37
    s_cselect_b32 s31, s69, s68
    s_add_u32 s32, s32, s31
    s_add_u32 s33, s33, s31
    s_add_u32 s34, s34, s31
    s_add_u32 s35, s35, s31
    s_add_u32 s36, s36, 49152
    s_cmp_ge_u32 s36, 147456
    s_cselect_b32 s31, 147456, 0
    s_sub_u32 s36, s36, s31
    s_branch B_AJ6
B_AUX6:
    s_waitcnt vmcnt(0)
    v_cmp_eq_u32 vcc, 0, v126
    s_cbranch_vccz B_RDY_D
    s_mov_b32 s39, 1000000
B_RDY_L:
    global_load_dword v126, v54, s[64:65] sc1
    s_waitcnt vmcnt(0)
    v_cmp_eq_u32 vcc, 0, v126
    s_cbranch_vccz B_RDY_D
    s_sub_u32 s39, s39, 1
    s_cbranch_scc1 B_RDY_D
    s_sleep 8
    s_branch B_RDY_L
B_RDY_D:
    v_not_b32 v127, v126
    s_lshl_b32 s31, s2, 4
    s_add_u32 s31, s31, 262144
    s_mov_b64 exec, 1
    buffer_store_dwordx2 v[126:127], v54, s[8:11], s31 offen sc1
    s_mov_b64 exec, -1
    buffer_load_dword v236, v123, s[16:19], s70 offen offset:256
B_AJ6:
    s_waitcnt lgkmcnt(0)
    v_mfma_f32_16x16x32_bf16 v[20:23], v[16:19], v[240:243], v[20:23]
    v_mfma_f32_16x16x32_bf16 v[20:23], v[16:19], v[244:247], v[20:23]
    v_mfma_f32_16x16x32_bf16 v[20:23], v[16:19], v[248:251], v[20:23]
    v_mfma_f32_16x16x32_bf16 v[20:23], v[16:19], v[252:255], v[20:23]
    s_cmp_eq_u32 s29, 3
    s_cbranch_scc1 B_NW7
    s_waitcnt vmcnt(16)
B_NW7:
    s_waitcnt lgkmcnt(0)
    s_barrier
    ds_read_b128 v[240:243], v24 offset:0
    ds_read_b128 v[244:247], v24 offset:2048
    ds_read_b128 v[248:251], v24 offset:4096
    ds_read_b128 v[252:255], v24 offset:6144
    s_cmp_eq_u32 s29, 3
    s_cbranch_scc1 B_AUX8
    s_add_u32 m0, s36, 0
    s_nop 0
    buffer_load_dwordx4 v4, s[12:15], s32 offen offset:0 lds
    buffer_load_dwordx4 v5, s[12:15], s32 offen offset:1024 lds
    buffer_load_dwordx4 v6, s[12:15], s32 offen offset:2048 lds
    buffer_load_dwordx4 v7, s[12:15], s32 offen offset:3072 lds
    s_add_u32 m0, s36, 4096
    s_nop 0
    buffer_load_dwordx4 v4, s[12:15], s33 offen offset:0 lds
    buffer_load_dwordx4 v5, s[12:15], s33 offen offset:1024 lds
    buffer_load_dwordx4 v6, s[12:15], s33 offen offset:2048 lds
    buffer_load_dwordx4 v7, s[12:15], s33 offen offset:3072 lds
    s_add_u32 m0, s36, 8192
    s_nop 0
    buffer_load_dwordx4 v8, s[20:23], s34 offen offset:0 lds
    buffer_load_dwordx4 v9, s[20:23], s34 offen offset:1024 lds
    buffer_load_dwordx4 v10, s[20:23], s34 offen offset:2048 lds
    buffer_load_dwordx4 v11, s[20:23], s34 offen offset:3072 lds
    s_add_u32 m0, s36, 12288
    s_nop 0
    buffer_load_dwordx4 v8, s[20:23], s35 offen offset:0 lds
    buffer_load_dwordx4 v9, s[20:23], s35 offen offset:1024 lds
    buffer_load_dwordx4 v10, s[20:23], s35 offen offset:2048 lds
    buffer_load_dwordx4 v11, s[20:23], s35 offen offset:3072 lds
    s_add_u32 s37, s37, 1
    s_cmp_eq_u32 s37, 8
    s_cselect_b32 s37, 0, s37
    s_cselect_b32 s31, s69, s68
    s_add_u32 s32, s32, s31
    s_add_u32 s33, s33, s31
    s_add_u32 s34, s34, s31
    s_add_u32 s35, s35, s31
    s_add_u32 s36, s36, 49152
    s_cmp_ge_u32 s36, 147456
    s_cselect_b32 s31, 147456, 0
    s_sub_u32 s36, s36, s31
    s_branch B_AJ8
B_AUX8:
    buffer_load_dword v236, v123, s[16:19], s70 offen offset:512
B_AJ8:
    s_waitcnt lgkmcnt(0)
    v_mfma_f32_16x16x32_bf16 v[20:23], v[16:19], v[240:243], v[20:23]
    v_mfma_f32_16x16x32_bf16 v[20:23], v[16:19], v[244:247], v[20:23]
    v_mfma_f32_16x16x32_bf16 v[20:23], v[16:19], v[248:251], v[20:23]
    v_mfma_f32_16x16x32_bf16 v[20:23], v[16:19], v[252:255], v[20:23]
    s_cmp_eq_u32 s29, 3
    s_cbranch_scc1 B_NW9
    s_waitcnt vmcnt(16)
B_NW9:
    s_waitcnt lgkmcnt(0)
    s_barrier
    ds_read_b128 v[240:243], v24 offset:49152
    ds_read_b128 v[244:247], v24 offset:51200
    ds_read_b128 v[248:251], v24 offset:53248
    ds_read_b128 v[252:255], v24 offset:55296
    s_cmp_eq_u32 s29, 3
    s_cbranch_scc1 B_AUX10
    s_add_u32 m0, s36, 0
    s_nop 0
    buffer_load_dwordx4 v4, s[12:15], s32 offen offset:0 lds
    buffer_load_dwordx4 v5, s[12:15], s32 offen offset:1024 lds
    buffer_load_dwordx4 v6, s[12:15], s32 offen offset:2048 lds
    buffer_load_dwordx4 v7, s[12:15], s32 offen offset:3072 lds
    s_add_u32 m0, s36, 4096
    s_nop 0
    buffer_load_dwordx4 v4, s[12:15], s33 offen offset:0 lds
    buffer_load_dwordx4 v5, s[12:15], s33 offen offset:1024 lds
    buffer_load_dwordx4 v6, s[12:15], s33 offen offset:2048 lds
    buffer_load_dwordx4 v7, s[12:15], s33 offen offset:3072 lds
    s_add_u32 m0, s36, 8192
    s_nop 0
    buffer_load_dwordx4 v8, s[20:23], s34 offen offset:0 lds
    buffer_load_dwordx4 v9, s[20:23], s34 offen offset:1024 lds
    buffer_load_dwordx4 v10, s[20:23], s34 offen offset:2048 lds
    buffer_load_dwordx4 v11, s[20:23], s34 offen offset:3072 lds
    s_add_u32 m0, s36, 12288
    s_nop 0
    buffer_load_dwordx4 v8, s[20:23], s35 offen offset:0 lds
    buffer_load_dwordx4 v9, s[20:23], s35 offen offset:1024 lds
    buffer_load_dwordx4 v10, s[20:23], s35 offen offset:2048 lds
    buffer_load_dwordx4 v11, s[20:23], s35 offen offset:3072 lds
    s_add_u32 s37, s37, 1
    s_cmp_eq_u32 s37, 8
    s_cselect_b32 s37, 0, s37
    s_cselect_b32 s31, s69, s68
    s_add_u32 s32, s32, s31
    s_add_u32 s33, s33, s31
    s_add_u32 s34, s34, s31
    s_add_u32 s35, s35, s31
    s_add_u32 s36, s36, 49152
    s_cmp_ge_u32 s36, 147456
    s_cselect_b32 s31, 147456, 0
    s_sub_u32 s36, s36, s31
    s_branch B_AJ10
B_AUX10:
    s_mov_b32 s72, 262144
    v_lshlrev_b32 v122, 4, v1
    buffer_load_dwordx2 v[112:113], v122, s[8:11], s72 offen offset:0 sc1
    buffer_load_dwordx2 v[114:115], v122, s[8:11], s72 offen offset:1024 sc1
    buffer_load_dwordx2 v[116:117], v122, s[8:11], s72 offen offset:2048 sc1
    buffer_load_dwordx2 v[118:119], v122, s[8:11], s72 offen offset:3072 sc1
    buffer_load_dword v236, v123, s[16:19], s70 offen offset:640
B_AJ10:
    s_waitcnt lgkmcnt(0)
    v_mfma_f32_16x16x32_bf16 v[20:23], v[16:19], v[240:243], v[20:23]
    v_mfma_f32_16x16x32_bf16 v[20:23], v[16:19], v[244:247], v[20:23]
    v_mfma_f32_16x16x32_bf16 v[20:23], v[16:19], v[248:251], v[20:23]
    v_mfma_f32_16x16x32_bf16 v[20:23], v[16:19], v[252:255], v[20:23]
    s_cmp_eq_u32 s29, 3
    s_cbranch_scc1 B_NW11
    s_waitcnt vmcnt(16)
B_NW11:
    s_waitcnt lgkmcnt(0)
    s_barrier
    ds_read_b128 v[240:243], v26 offset:0
    ds_read_b128 v[244:247], v26 offset:2048
    ds_read_b128 v[248:251], v26 offset:4096
    ds_read_b128 v[252:255], v26 offset:6144
    s_cmp_eq_u32 s29, 3
    s_cbranch_scc1 B_AUX12
    s_add_u32 m0, s36, 0
    s_nop 0
    buffer_load_dwordx4 v4, s[12:15], s32 offen offset:0 lds
    buffer_load_dwordx4 v5, s[12:15], s32 offen offset:1024 lds
    buffer_load_dwordx4 v6, s[12:15], s32 offen offset:2048 lds
    buffer_load_dwordx4 v7, s[12:15], s32 offen offset:3072 lds
    s_add_u32 m0, s36, 4096
    s_nop 0
    buffer_load_dwordx4 v4, s[12:15], s33 offen offset:0 lds
    buffer_load_dwordx4 v5, s[12:15], s33 offen offset:1024 lds
    buffer_load_dwordx4 v6, s[12:15], s33 offen offset:2048 lds
    buffer_load_dwordx4 v7, s[12:15], s33 offen offset:3072 lds
    s_add_u32 m0, s36, 8192
    s_nop 0
    buffer_load_dwordx4 v8, s[20:23], s34 offen offset:0 lds
    buffer_load_dwordx4 v9, s[20:23], s34 offen offset:1024 lds
    buffer_load_dwordx4 v10, s[20:23], s34 offen offset:2048 lds
    buffer_load_dwordx4 v11, s[20:23], s34 offen offset:3072 lds
    s_add_u32 m0, s36, 12288
    s_nop 0
    buffer_load_dwordx4 v8, s[20:23], s35 offen offset:0 lds
    buffer_load_dwordx4 v9, s[20:23], s35 offen offset:1024 lds
    buffer_load_dwordx4 v10, s[20:23], s35 offen offset:2048 lds
    buffer_load_dwordx4 v11, s[20:23], s35 offen offset:3072 lds
    s_add_u32 s37, s37, 1
    s_cmp_eq_u32 s37, 8
    s_cselect_b32 s37, 0, s37
    s_cselect_b32 s31, s69, s68
    s_add_u32 s32, s32, s31
    s_add_u32 s33, s33, s31
    s_add_u32 s34, s34, s31
    s_add_u32 s35, s35, s31
    s_add_u32 s36, s36, 49152
    s_cmp_ge_u32 s36, 147456
    s_cselect_b32 s31, 147456, 0
    s_sub_u32 s36, s36, s31
    s_branch B_AJ12
B_AUX12:
    s_waitcnt vmcnt(1)
    v_cmp_ne_u64 vcc, v[112:113], v[126:127]
    v_cmp_ne_u64 s[74:75], v[114:115], v[126:127]
    s_nop 0
    s_or_b64 vcc, vcc, s[74:75]
    v_cmp_ne_u64 s[74:75], v[116:117], v[126:127]
    s_nop 0
    s_or_b64 vcc, vcc, s[74:75]
    v_cmp_ne_u64 s[74:75], v[118:119], v[126:127]
    s_nop 0
    s_or_b64 vcc, vcc, s[74:75]
    s_cbranch_vccz B_LNF_D
    s_mov_b32 s39, 1000000
B_LNF_L:
    s_mov_b32 s72, 262144
    v_lshlrev_b32 v122, 4, v1
    buffer_load_dwordx2 v[112:113], v122, s[8:11], s72 offen offset:0 sc1
    buffer_load_dwordx2 v[114:115], v122, s[8:11], s72 offen offset:1024 sc1
    buffer_load_dwordx2 v[116:117], v122, s[8:11], s72 offen offset:2048 sc1
    buffer_load_dwordx2 v[118:119], v122, s[8:11], s72 offen offset:3072 sc1
    s_waitcnt vmcnt(0)
    v_cmp_ne_u64 vcc, v[112:113], v[126:127]
    v_cmp_ne_u64 s[74:75], v[114:115], v[126:127]
    s_nop 0
    s_or_b64 vcc, vcc, s[74:75]
    v_cmp_ne_u64 s[74:75], v[116:117], v[126:127]
    s_nop 0
    s_or_b64 vcc, vcc, s[74:75]
    v_cmp_ne_u64 s[74:75], v[118:119], v[126:127]
    s_nop 0
    s_or_b64 vcc, vcc, s[74:75]
    s_cbranch_vccz B_LNF_D
    s_sub_u32 s39, s39, 1
    s_cbranch_scc1 B_LNF_D
    s_sleep 16
    s_branch B_LNF_L
B_LNF_D:
    v_mov_b32 v49, 163584
    ds_write_b64 v49, v[126:127] offset:32
    buffer_load_dword v236, v123, s[16:19], s70 offen offset:768
B_AJ12:
    v_and_b32 v50, 127, v27
    v_lshlrev_b32 v51, 7, v27
    v_subrev_u32 v52, 120, v51
    v_max_i32 v52, 0, v52
    v_lshlrev_b32 v57, 3, v27
    v_mul_u32_u24 v44, 2731, v27
    v_lshrrev_b32 v44, 16, v44
    v_mul_u32_u24 v49, 24, v44
    v_sub_u32 v49, v27, v49
    v_mul_u32_u24 v44, 4640, v44
    v_lshl_add_u32 v44, v49, 4, v44
    v_mul_u32_u24 v55, 61184, v3
    v_add_u32 v55, 86272, v55
    v_lshl_add_u32 v45, v50, 3, v55
    v_lshlrev_b32 v46, 4, v27
    v_add_u32 v46, 49152, v46
    v_and_b32 v48, 3, v1
    v_lshl_add_u32 v48, v3, 2, v48
    v_lshlrev_b32 v48, 5, v48
    v_and_b32 v49, 1, v2
    v_lshl_add_u32 v48, v49, 8, v48
    v_bfe_u32 v49, v1, 4, 1
    v_lshl_add_u32 v48, v49, 4, v48
    v_add_u32 v48, 163072, v48
    v_mov_b32 v49, 163584
    v_mov_b32 v47, 1
    v_add_u32 v43, 160768, v57
    v_lshrrev_b32 v40, 3, v1
    v_and_b32 v41, 7, v1
    v_bfe_u32 v42, v1, 4, 1
    v_lshlrev_b32 v42, 2, v42
    v_xor_b32 v41, v41, v42
    v_lshlrev_b32 v40, 10, v40
    v_lshl_add_u32 v40, v41, 4, v40
    v_add_u32 v41, 7168, v40
    v_lshrrev_b32 v38, 5, v1
    v_bfe_u32 v39, v1, 2, 2
    v_lshl_add_u32 v38, v38, 2, v39
    v_lshlrev_b32 v38, 7, v38
    v_lshrrev_b32 v39, 1, v39
    v_lshl_add_u32 v38, v39, 6, v38
    v_bfe_u32 v39, v1, 4, 1
    v_lshl_add_u32 v38, v39, 5, v38
    v_and_b32 v39, 3, v1
    v_lshl_add_u32 v38, v39, 3, v38
    v_xor_b32 v39, 64, v38
    s_waitcnt lgkmcnt(0)
    v_mfma_f32_16x16x32_bf16 v[20:23], v[16:19], v[240:243], v[20:23]
    v_mfma_f32_16x16x32_bf16 v[20:23], v[16:19], v[244:247], v[20:23]
    v_mfma_f32_16x16x32_bf16 v[20:23], v[16:19], v[248:251], v[20:23]
    v_mfma_f32_16x16x32_bf16 v[20:23], v[16:19], v[252:255], v[20:23]
    s_xor_b32 s27, s27, 4
    s_mul_i32 s32, s29, 458752
    s_lshl_b32 s31, s27, 7
    s_add_u32 s32, s32, s31
    s_mul_i32 s35, s29, 12288
    s_add_u32 s34, s35, 98304
    v_mov_b32 v4, v40
    v_mov_b32 v5, v41
    v_add_u32 v6, s34, v38
    v_add_u32 v7, s34, v39
    v_add_u32 v8, s35, v38
    v_add_u32 v9, s35, v39
    s_lshr_b32 s36, s77, 2
    s_lshl_b32 s36, s36, 15
    s_and_b32 s30, s77, 3
    s_lshl_b32 s30, s30, 5
    s_add_u32 s36, s36, s30
    s_add_u32 s36, s36, 1048576
    s_add_u32 s30, s36, 16384
    s_sub_u32 s71, s30, 120
    s_lshl_b32 s70, s24, 11
    s_cmp_eq_u32 s29, 3
    s_cbranch_scc1 B_NW13
    s_waitcnt vmcnt(16)
B_NW13:
    s_waitcnt lgkmcnt(0)
    s_barrier
    ds_read_b64 v[14:15], v49 offset:32
    ds_read_b128 v[240:243], v24 offset:0
    ds_read_b128 v[244:247], v24 offset:2048
    ds_read_b128 v[248:251], v24 offset:4096
    ds_read_b128 v[252:255], v24 offset:6144
    s_cmp_eq_u32 s29, 3
    s_cbranch_scc1 B_K6
    s_waitcnt vmcnt(0)
B_K6:
    buffer_load_dwordx2 v[124:125], v57, s[8:11], s70 offen offset:0 sc1
    buffer_load_dwordx4 v[60:63], v51, s[8:11], s36 offen sc1
    buffer_load_dwordx4 v[68:71], v51, s[8:11], s36 offen offset:16 sc1
    s_mov_b64 exec, 1
    buffer_load_dwordx2 v[58:59], v52, s[8:11], s36 offen sc1
    buffer_load_dwordx2 v[66:67], v52, s[8:11], s36 offen offset:16 sc1
    s_mov_b64 exec, -1
    s_waitcnt lgkmcnt(0)
    v_mfma_f32_16x16x32_bf16 v[20:23], v[16:19], v[240:243], v[20:23]
    v_mfma_f32_16x16x32_bf16 v[20:23], v[16:19], v[244:247], v[20:23]
    v_mfma_f32_16x16x32_bf16 v[20:23], v[16:19], v[248:251], v[20:23]
    v_mfma_f32_16x16x32_bf16 v[20:23], v[16:19], v[252:255], v[20:23]
    s_cmp_eq_u32 s29, 3
    s_cbranch_scc1 B_NW14
    s_waitcnt vmcnt(63)
B_NW14:
    s_waitcnt lgkmcnt(0)
    s_barrier
    s_waitcnt vmcnt(4)
    ds_write_b64 v43, v[124:125]
    s_mov_b32 s30, 192
    ds_read_b128 v[240:243], v24 offset:49152
    ds_read_b128 v[244:247], v24 offset:51200
    ds_read_b128 v[248:251], v24 offset:53248
    ds_read_b128 v[252:255], v24 offset:55296
    s_waitcnt lgkmcnt(0)
    v_mfma_f32_16x16x32_bf16 v[20:23], v[16:19], v[240:243], v[20:23]
    v_mfma_f32_16x16x32_bf16 v[20:23], v[16:19], v[244:247], v[20:23]
    v_mfma_f32_16x16x32_bf16 v[20:23], v[16:19], v[248:251], v[20:23]
    v_mfma_f32_16x16x32_bf16 v[20:23], v[16:19], v[252:255], v[20:23]
    s_nop 7
    v_add_f32_dpp v20, v20, v20 row_ror:4 row_mask:0xf bank_mask:0xf
    v_add_f32_dpp v21, v21, v21 row_ror:4 row_mask:0xf bank_mask:0xf
    v_add_f32_dpp v22, v22, v22 row_ror:4 row_mask:0xf bank_mask:0xf
    v_add_f32_dpp v23, v23, v23 row_ror:4 row_mask:0xf bank_mask:0xf
    v_add_f32_dpp v20, v20, v20 row_ror:8 row_mask:0xf bank_mask:0xf
    v_add_f32_dpp v21, v21, v21 row_ror:8 row_mask:0xf bank_mask:0xf
    v_add_f32_dpp v22, v22, v22 row_ror:8 row_mask:0xf bank_mask:0xf
    v_add_f32_dpp v23, v23, v23 row_ror:8 row_mask:0xf bank_mask:0xf
    ds_write_b128 v48, v[20:23]
    s_waitcnt vmcnt(0)
    s_add_u32 m0, s34, 0
    s_add_u32 s33, s32, 0
    buffer_load_dwordx4 v4, s[16:19], s33 offen lds
    v_cmp_eq_u32 vcc, 0, v27
    s_nop 1
    v_cndmask_b32 v58, v58, v232, vcc
    s_nop 1
    v_mov_b32_dpp v58, v62 wave_shr:1 row_mask:0xf bank_mask:0xf
    v_cndmask_b32 v59, v59, v232, vcc
    s_nop 1
    v_mov_b32_dpp v59, v63 wave_shr:1 row_mask:0xf bank_mask:0xf
    v_cndmask_b32 v66, v66, v232, vcc
    buffer_load_dwordx4 v5, s[16:19], s33 offen offset:1024 lds
    s_nop 0
    v_mov_b32_dpp v66, v70 wave_shr:1 row_mask:0xf bank_mask:0xf
    v_cndmask_b32 v67, v67, v232, vcc
    s_nop 1
    v_mov_b32_dpp v67, v71 wave_shr:1 row_mask:0xf bank_mask:0xf
    v_alignbit_b32 v200, v60, v59, 16
    v_mov_b32 v204, v59
    v_alignbit_b32 v208, v59, v58, 16
    s_add_u32 m0, s34, 2048
    s_add_u32 s33, s32, 16384
    buffer_load_dwordx4 v4, s[16:19], s33 offen lds
    v_alignbit_b32 v201, v61, v60, 16
    v_mov_b32 v205, v60
    v_alignbit_b32 v209, v60, v59, 16
    v_alignbit_b32 v202, v62, v61, 16
    v_mov_b32 v206, v61
    v_alignbit_b32 v210, v61, v60, 16
    buffer_load_dwordx4 v5, s[16:19], s33 offen offset:1024 lds
    v_alignbit_b32 v203, v63, v62, 16
    v_mov_b32 v207, v62
    v_alignbit_b32 v211, v62, v61, 16
    v_alignbit_b32 v212, v68, v67, 16
    v_mov_b32 v216, v67
    v_alignbit_b32 v220, v67, v66, 16
    s_add_u32 m0, s34, 4096
    s_add_u32 s33, s32, 65536
    buffer_load_dwordx4 v4, s[16:19], s33 offen lds
    v_alignbit_b32 v213, v69, v68, 16
    v_mov_b32 v217, v68
    v_alignbit_b32 v221, v68, v67, 16
    v_alignbit_b32 v214, v70, v69, 16
    v_mov_b32 v218, v69
    v_alignbit_b32 v222, v69, v68, 16
    buffer_load_dwordx4 v5, s[16:19], s33 offen offset:1024 lds
    v_alignbit_b32 v215, v71, v70, 16
    v_mov_b32 v219, v70
    v_alignbit_b32 v223, v70, v69, 16
    v_cmp_gt_u32 s[68:69], s30, v27
    v_cmp_gt_u32 s[70:71], 15, v50
    s_waitcnt lgkmcnt(0)
    s_barrier
    s_add_u32 m0, s34, 6144
    s_add_u32 s33, s32, 81920
    buffer_load_dwordx4 v4, s[16:19], s33 offen lds
    buffer_load_dwordx4 v5, s[16:19], s33 offen offset:1024 lds
    s_add_u32 m0, s34, 8192
    s_add_u32 s33, s32, 131072
    buffer_load_dwordx4 v4, s[16:19], s33 offen lds
    buffer_load_dwordx4 v5, s[16:19], s33 offen offset:1024 lds
    s_add_u32 m0, s34, 10240
    s_add_u32 s33, s32, 147456
    buffer_load_dwordx4 v4, s[16:19], s33 offen lds
    buffer_load_dwordx4 v5, s[16:19], s33 offen offset:1024 lds
    s_add_u32 m0, s35, 0
    s_add_u32 s33, s32, 196608
    buffer_load_dwordx4 v4, s[16:19], s33 offen lds
    buffer_load_dwordx4 v5, s[16:19], s33 offen offset:1024 lds
    s_add_u32 m0, s35, 2048
    s_add_u32 s33, s32, 212992
    buffer_load_dwordx4 v4, s[16:19], s33 offen lds
    buffer_load_dwordx4 v5, s[16:19], s33 offen offset:1024 lds
    s_add_u32 m0, s35, 4096
    s_add_u32 s33, s32, 262144
    buffer_load_dwordx4 v4, s[16:19], s33 offen lds
    buffer_load_dwordx4 v5, s[16:19], s33 offen offset:1024 lds
    s_add_u32 m0, s35, 6144
    s_add_u32 s33, s32, 278528
    buffer_load_dwordx4 v4, s[16:19], s33 offen lds
    buffer_load_dwordx4 v5, s[16:19], s33 offen offset:1024 lds
    s_add_u32 m0, s35, 8192
    s_add_u32 s33, s32, 327680
    buffer_load_dwordx4 v4, s[16:19], s33 offen lds
    buffer_load_dwordx4 v5, s[16:19], s33 offen offset:1024 lds
    s_add_u32 m0, s35, 10240
    s_add_u32 s33, s32, 344064
    buffer_load_dwordx4 v4, s[16:19], s33 offen lds
    buffer_load_dwordx4 v5, s[16:19], s33 offen offset:1024 lds
    ds_write_b128 v46, v[60:63] offset:14304
    ds_write_b128 v46, v[200:203] offset:9664
    ds_write_b128 v46, v[204:207] offset:5024
    ds_write_b128 v46, v[208:211] offset:384
    ds_write_b128 v46, v[68:71] offset:32864
    ds_write_b128 v46, v[212:215] offset:28224
    ds_write_b128 v46, v[216:219] offset:23584
    ds_write_b128 v46, v[220:223] offset:18944
    s_mov_b64 exec, s[68:69]
    ds_write_b128 v44, v[232:235] offset:49152
    s_mov_b64 exec, s[70:71]
    ds_write_b64 v45, v[232:233] offset:4096
    ds_write_b64 v45, v[232:233] offset:8312
    s_mov_b64 exec, 1
    ds_add_u32 v49, v47
    s_mov_b64 exec, -1
    s_waitcnt vmcnt(12)
    ds_read_b64_tr_b16 v[96:97], v6 offset:0
    ds_read_b64_tr_b16 v[98:99], v6 offset:1024
    ds_read_b64_tr_b16 v[100:101], v7 offset:0
    ds_read_b64_tr_b16 v[102:103], v7 offset:1024
    ds_read_b64_tr_b16 v[104:105], v6 offset:2048
    ds_read_b64_tr_b16 v[106:107], v6 offset:3072
    ds_read_b64_tr_b16 v[108:109], v7 offset:2048
    ds_read_b64_tr_b16 v[110:111], v7 offset:3072
    ds_read_b64_tr_b16 v[112:113], v6 offset:4096
    ds_read_b64_tr_b16 v[114:115], v6 offset:5120
    ds_read_b64_tr_b16 v[116:117], v7 offset:4096
    ds_read_b64_tr_b16 v[118:119], v7 offset:5120
    ds_read_b64_tr_b16 v[120:121], v6 offset:6144
    ds_read_b64_tr_b16 v[122:123], v6 offset:7168
    ds_read_b64_tr_b16 v[124:125], v7 offset:6144
    ds_read_b64_tr_b16 v[126:127], v7 offset:7168
    ds_read_b64_tr_b16 v[128:129], v6 offset:8192
    ds_read_b64_tr_b16 v[130:131], v6 offset:9216
    ds_read_b64_tr_b16 v[132:133], v7 offset:8192
    ds_read_b64_tr_b16 v[134:135], v7 offset:9216
    ds_read_b64_tr_b16 v[136:137], v6 offset:10240
    ds_read_b64_tr_b16 v[138:139], v6 offset:11264
    ds_read_b64_tr_b16 v[140:141], v7 offset:10240
    ds_read_b64_tr_b16 v[142:143], v7 offset:11264
    s_waitcnt lgkmcnt(0)
    s_add_u32 m0, s34, 0
    s_add_u32 s33, s32, 393216
    buffer_load_dwordx4 v4, s[16:19], s33 offen lds
    buffer_load_dwordx4 v5, s[16:19], s33 offen offset:1024 lds
    s_add_u32 m0, s34, 2048
    s_add_u32 s33, s32, 409600
    buffer_load_dwordx4 v4, s[16:19], s33 offen lds
    buffer_load_dwordx4 v5, s[16:19], s33 offen offset:1024 lds
    s_add_u32 m0, s34, 4096
    s_add_u32 s33, s32, 32768
    buffer_load_dwordx4 v4, s[16:19], s33 offen lds
    buffer_load_dwordx4 v5, s[16:19], s33 offen offset:1024 lds
    s_add_u32 m0, s34, 6144
    s_add_u32 s33, s32, 49152
    buffer_load_dwordx4 v4, s[16:19], s33 offen lds
    buffer_load_dwordx4 v5, s[16:19], s33 offen offset:1024 lds
    s_add_u32 m0, s34, 8192
    s_add_u32 s33, s32, 98304
    buffer_load_dwordx4 v4, s[16:19], s33 offen lds
    buffer_load_dwordx4 v5, s[16:19], s33 offen offset:1024 lds
    s_add_u32 m0, s34, 10240
    s_add_u32 s33, s32, 114688
    buffer_load_dwordx4 v4, s[16:19], s33 offen lds
    buffer_load_dwordx4 v5, s[16:19], s33 offen offset:1024 lds
    s_waitcnt vmcnt(12)
    ds_read_b64_tr_b16 v[144:145], v8 offset:0
    ds_read_b64_tr_b16 v[146:147], v8 offset:1024
    ds_read_b64_tr_b16 v[148:149], v9 offset:0
    ds_read_b64_tr_b16 v[150:151], v9 offset:1024
    ds_read_b64_tr_b16 v[152:153], v8 offset:2048
    ds_read_b64_tr_b16 v[154:155], v8 offset:3072
    ds_read_b64_tr_b16 v[156:157], v9 offset:2048
    ds_read_b64_tr_b16 v[158:159], v9 offset:3072
    ds_read_b64_tr_b16 v[160:161], v8 offset:4096
    ds_read_b64_tr_b16 v[162:163], v8 offset:5120
    ds_read_b64_tr_b16 v[164:165], v9 offset:4096
    ds_read_b64_tr_b16 v[166:167], v9 offset:5120
    ds_read_b64_tr_b16 v[168:169], v8 offset:6144
    ds_read_b64_tr_b16 v[170:171], v8 offset:7168
    ds_read_b64_tr_b16 v[172:173], v9 offset:6144
    ds_read_b64_tr_b16 v[174:175], v9 offset:7168
    ds_read_b64_tr_b16 v[176:177], v8 offset:8192
    ds_read_b64_tr_b16 v[178:179], v8 offset:9216
    ds_read_b64_tr_b16 v[180:181], v9 offset:8192
    ds_read_b64_tr_b16 v[182:183], v9 offset:9216
    ds_read_b64_tr_b16 v[184:185], v8 offset:10240
    ds_read_b64_tr_b16 v[186:187], v8 offset:11264
    ds_read_b64_tr_b16 v[188:189], v9 offset:10240
    ds_read_b64_tr_b16 v[190:191], v9 offset:11264
    s_waitcnt lgkmcnt(0)
    s_add_u32 m0, s35, 0
    s_add_u32 s33, s32, 163840
    buffer_load_dwordx4 v4, s[16:19], s33 offen lds
    buffer_load_dwordx4 v5, s[16:19], s33 offen offset:1024 lds
    s_add_u32 m0, s35, 2048
    s_add_u32 s33, s32, 180224
    buffer_load_dwordx4 v4, s[16:19], s33 offen lds
    buffer_load_dwordx4 v5, s[16:19], s33 offen offset:1024 lds
    s_add_u32 m0, s35, 4096
    s_add_u32 s33, s32, 229376
    buffer_load_dwordx4 v4, s[16:19], s33 offen lds
    buffer_load_dwordx4 v5, s[16:19], s33 offen offset:1024 lds
    s_add_u32 m0, s35, 6144
    s_add_u32 s33, s32, 245760
    buffer_load_dwordx4 v4, s[16:19], s33 offen lds
    buffer_load_dwordx4 v5, s[16:19], s33 offen offset:1024 lds
    s_add_u32 m0, s35, 8192
    s_add_u32 s33, s32, 294912
    buffer_load_dwordx4 v4, s[16:19], s33 offen lds
    buffer_load_dwordx4 v5, s[16:19], s33 offen offset:1024 lds
    s_add_u32 m0, s35, 10240
    s_add_u32 s33, s32, 311296
    buffer_load_dwordx4 v4, s[16:19], s33 offen lds
    buffer_load_dwordx4 v5, s[16:19], s33 offen offset:1024 lds
    s_setprio 0
    v_lshrrev_b32 v10, 3, v1
    v_min_u32 v10, 6, v10
    v_lshlrev_b32 v10, 7, v10
    v_bfe_u32 v11, v1, 2, 1
    v_lshl_add_u32 v10, v11, 3, v10
    s_mul_i32 s37, s26, 3584
    s_mul_i32 s30, s29, 896
    s_add_u32 s37, s37, s30
    s_add_u32 s37, s37, 327680
    s_lshl_b32 s36, s26, 1
    s_mul_i32 s36, s36, 112
    s_mul_i32 s30, s29, 28
    s_add_u32 s36, s36, s30
    s_lshl_b32 s36, s36, 10
    s_add_u32 s36, s36, 4194304
    s_lshl_b32 s70, s27, 7
    s_add_u32 s70, s70, s36
    s_mov_b32 s20, s62
    s_mov_b32 s21, s63
    s_mov_b32 s22, 0x200000
    s_mov_b32 s23, 0x00020000
    v_lshrrev_b32 v11, 1, v1
    v_lshlrev_b32 v11, 10, v11
    v_and_b32 v12, 1, v1
    v_mul_u32_u24 v12, 114688, v12
    v_add_u32 v11, v11, v12
    s_lshl_b32 s71, s26, 16
    s_lshl_b32 s30, s27, 7
    s_add_u32 s71, s71, s30
    v_bfe_u32 v12, v0, 2, 6
    v_lshlrev_b32 v12, 10, v12
    buffer_load_dword v3, v12, s[4:7], s71 offen
    s_mov_b32 s72, -1
    s_mov_b32 s73, 0xffffff
    s_mov_b32 s39, 1000000
    s_waitcnt vmcnt(17) lgkmcnt(0)
    ds_read_b64_tr_b16 v[88:89], v6 offset:0
    ds_read_b64_tr_b16 v[90:91], v6 offset:1024
    ds_read_b64_tr_b16 v[92:93], v7 offset:0
    ds_read_b64_tr_b16 v[94:95], v7 offset:1024
    ds_read_b64_tr_b16 v[80:81], v6 offset:2048
    ds_read_b64_tr_b16 v[82:83], v6 offset:3072
    ds_read_b64_tr_b16 v[84:85], v7 offset:2048
    ds_read_b64_tr_b16 v[86:87], v7 offset:3072
    ds_read_b64_tr_b16 v[72:73], v6 offset:4096
    ds_read_b64_tr_b16 v[74:75], v6 offset:5120
    ds_read_b64_tr_b16 v[76:77], v7 offset:4096
    ds_read_b64_tr_b16 v[78:79], v7 offset:5120
    ds_read_b64_tr_b16 v[64:65], v6 offset:6144
    ds_read_b64_tr_b16 v[66:67], v6 offset:7168
    ds_read_b64_tr_b16 v[68:69], v7 offset:6144
    ds_read_b64_tr_b16 v[70:71], v7 offset:7168
    buffer_load_dwordx2 v[12:13], v10, s[8:11], s37 offen sc1
    s_waitcnt lgkmcnt(0)
    s_add_u32 m0, s34, 0
    s_add_u32 s33, s32, 360448
    buffer_load_dwordx4 v4, s[16:19], s33 offen lds
    buffer_load_dwordx4 v5, s[16:19], s33 offen offset:1024 lds
    s_add_u32 m0, s34, 2048
    s_add_u32 s33, s32, 376832
    buffer_load_dwordx4 v4, s[16:19], s33 offen lds
    buffer_load_dwordx4 v5, s[16:19], s33 offen offset:1024 lds
    s_add_u32 m0, s34, 4096
    s_add_u32 s33, s32, 425984
    buffer_load_dwordx4 v4, s[16:19], s33 offen lds
    buffer_load_dwordx4 v5, s[16:19], s33 offen offset:1024 lds
    s_add_u32 m0, s34, 6144
    s_add_u32 s33, s32, 442368
    buffer_load_dwordx4 v4, s[16:19], s33 offen lds
    buffer_load_dwordx4 v5, s[16:19], s33 offen offset:1024 lds
    s_mov_b32 s33, s37
    v_mov_b32 v4, v10
    v_mov_b32 v5, v11
    s_waitcnt vmcnt(8)
    v_cmp_eq_u64 vcc, v[12:13], v[14:15]
    s_nop 0
    s_and_b64 s[74:75], vcc, s[72:73]
    s_andn2_b64 s[72:73], s[72:73], vcc
    s_cmp_eq_u64 s[74:75], 0
    s_cbranch_scc1 B_F0
    s_mov_b64 exec, s[74:75]
    buffer_load_dword v3, v5, s[8:11], s70 offen sc1
    s_mov_b64 exec, -1
    s_mov_b64 s[74:75], 0
B_F0:
    s_bitcmp0_b32 s72, 0
    s_cbranch_scc1 B_HF_D0
B_HF_L0:
    buffer_load_dwordx2 v[12:13], v4, s[8:11], s33 offen sc1
    s_cmp_eq_u64 s[74:75], 0
    s_cbranch_scc1 B_HF_W0
    s_mov_b64 exec, s[74:75]
    buffer_load_dword v3, v5, s[8:11], s70 offen sc1
    s_mov_b64 exec, -1
    s_waitcnt vmcnt(1)
    s_branch B_HF_X0
B_HF_W0:
    s_waitcnt vmcnt(0)
B_HF_X0:
    v_cmp_eq_u64 vcc, v[12:13], v[14:15]
    s_nop 0
    s_and_b64 s[74:75], vcc, s[72:73]
    s_andn2_b64 s[72:73], s[72:73], vcc
    s_bitcmp0_b32 s72, 0
    s_cbranch_scc1 B_HF_E0
    s_sub_u32 s39, s39, 1
    s_cbranch_scc1 B_HF_E0
    s_sleep 1
    s_branch B_HF_L0
B_HF_E0:
    s_cmp_eq_u64 s[74:75], 0
    s_cbranch_scc1 B_HF_D0
    s_mov_b64 exec, s[74:75]
    buffer_load_dword v3, v5, s[8:11], s70 offen sc1
    s_mov_b64 exec, -1
    s_mov_b64 s[74:75], 0
B_HF_D0:
    s_bitcmp0_b32 s72, 8
    s_cbranch_scc1 B_HF_D1
B_HF_L1:
    buffer_load_dwordx2 v[12:13], v4, s[8:11], s33 offen sc1
    s_cmp_eq_u64 s[74:75], 0
    s_cbranch_scc1 B_HF_W1
    s_mov_b64 exec, s[74:75]
    buffer_load_dword v3, v5, s[8:11], s70 offen sc1
    s_mov_b64 exec, -1
    s_waitcnt vmcnt(1)
    s_branch B_HF_X1
B_HF_W1:
    s_waitcnt vmcnt(0)
B_HF_X1:
    v_cmp_eq_u64 vcc, v[12:13], v[14:15]
    s_nop 0
    s_and_b64 s[74:75], vcc, s[72:73]
    s_andn2_b64 s[72:73], s[72:73], vcc
    s_bitcmp0_b32 s72, 8
    s_cbranch_scc1 B_HF_E1
    s_sub_u32 s39, s39, 1
    s_cbranch_scc1 B_HF_E1
    s_sleep 1
    s_branch B_HF_L1
B_HF_E1:
    s_cmp_eq_u64 s[74:75], 0
    s_cbranch_scc1 B_HF_D1
    s_mov_b64 exec, s[74:75]
    buffer_load_dword v3, v5, s[8:11], s70 offen sc1
    s_mov_b64 exec, -1
    s_mov_b64 s[74:75], 0
B_HF_D1:
    v_lshlrev_b32 v10, 4, v1
    v_add_u32 v11, 114688, v10
    s_add_u32 s31, s36, 0
    buffer_load_dwordx4 v[32:35], v10, s[8:11], s31 offen sc1
    buffer_load_dwordx4 v[36:39], v11, s[8:11], s31 offen sc1
    s_add_u32 s31, s36, 1024
    buffer_load_dwordx4 v[40:43], v10, s[8:11], s31 offen sc1
    buffer_load_dwordx4 v[44:47], v11, s[8:11], s31 offen sc1
    s_add_u32 s31, s36, 4096
    buffer_load_dwordx4 v[48:51], v10, s[8:11], s31 offen sc1
    buffer_load_dwordx4 v[52:55], v11, s[8:11], s31 offen sc1
    s_add_u32 s31, s36, 5120
    buffer_load_dwordx4 v[56:59], v10, s[8:11], s31 offen sc1
    buffer_load_dwordx4 v[60:63], v11, s[8:11], s31 offen sc1
    s_waitcnt vmcnt(6)
    v_mfma_f32_32x32x16_bf16 v[192:207], v[96:99], v[32:35], 0
    v_mfma_f32_32x32x16_bf16 v[208:223], v[96:99], v[36:39], 0
    v_mfma_f32_32x32x16_bf16 v[224:239], v[100:103], v[32:35], 0
    v_mfma_f32_32x32x16_bf16 v[240:255], v[100:103], v[36:39], 0
    s_bitcmp0_b32 s72, 16
    s_cbranch_scc1 B_HF_D2
B_HF_L2:
    buffer_load_dwordx2 v[12:13], v4, s[8:11], s33 offen sc1
    s_cmp_eq_u64 s[74:75], 0
    s_cbranch_scc1 B_HF_W2
    s_mov_b64 exec, s[74:75]
    buffer_load_dword v3, v5, s[8:11], s70 offen sc1
    s_mov_b64 exec, -1
    s_waitcnt vmcnt(1)
    s_branch B_HF_X2
B_HF_W2:
    s_waitcnt vmcnt(0)
B_HF_X2:
    v_cmp_eq_u64 vcc, v[12:13], v[14:15]
    s_nop 0
    s_and_b64 s[74:75], vcc, s[72:73]
    s_andn2_b64 s[72:73], s[72:73], vcc
    s_bitcmp0_b32 s72, 16
    s_cbranch_scc1 B_HF_E2
    s_sub_u32 s39, s39, 1
    s_cbranch_scc1 B_HF_E2
    s_sleep 1
    s_branch B_HF_L2
B_HF_E2:
    s_cmp_eq_u64 s[74:75], 0
    s_cbranch_scc1 B_HF_D2
    s_mov_b64 exec, s[74:75]
    buffer_load_dword v3, v5, s[8:11], s70 offen sc1
    s_mov_b64 exec, -1
    s_mov_b64 s[74:75], 0
B_HF_D2:
    s_add_u32 s31, s36, 8192
    buffer_load_dwordx4 v[32:35], v10, s[8:11], s31 offen sc1
    buffer_load_dwordx4 v[36:39], v11, s[8:11], s31 offen sc1
    s_add_u32 s31, s36, 9216
    buffer_load_dwordx4 v[96:99], v10, s[8:11], s31 offen sc1
    buffer_load_dwordx4 v[100:103], v11, s[8:11], s31 offen sc1
    s_waitcnt vmcnt(8)
    v_mfma_f32_32x32x16_bf16 v[192:207], v[104:107], v[40:43], v[192:207]
    v_mfma_f32_32x32x16_bf16 v[208:223], v[104:107], v[44:47], v[208:223]
    v_mfma_f32_32x32x16_bf16 v[224:239], v[108:111], v[40:43], v[224:239]
    v_mfma_f32_32x32x16_bf16 v[240:255], v[108:111], v[44:47], v[240:255]
    s_bitcmp0_b32 s72, 24
    s_cbranch_scc1 B_HF_D3
B_HF_L3:
    buffer_load_dwordx2 v[12:13], v4, s[8:11], s33 offen sc1
    s_cmp_eq_u64 s[74:75], 0
    s_cbranch_scc1 B_HF_W3
    s_mov_b64 exec, s[74:75]
    buffer_load_dword v3, v5, s[8:11], s70 offen sc1
    s_mov_b64 exec, -1
    s_waitcnt vmcnt(1)
    s_branch B_HF_X3
B_HF_W3:
    s_waitcnt vmcnt(0)
B_HF_X3:
    v_cmp_eq_u64 vcc, v[12:13], v[14:15]
    s_nop 0
    s_and_b64 s[74:75], vcc, s[72:73]
    s_andn2_b64 s[72:73], s[72:73], vcc
    s_bitcmp0_b32 s72, 24
    s_cbranch_scc1 B_HF_E3
    s_sub_u32 s39, s39, 1
    s_cbranch_scc1 B_HF_E3
    s_sleep 1
    s_branch B_HF_L3
B_HF_E3:
    s_cmp_eq_u64 s[74:75], 0
    s_cbranch_scc1 B_HF_D3
    s_mov_b64 exec, s[74:75]
    buffer_load_dword v3, v5, s[8:11], s70 offen sc1
    s_mov_b64 exec, -1
    s_mov_b64 s[74:75], 0
B_HF_D3:
    s_add_u32 s31, s36, 12288
    buffer_load_dwordx4 v[40:43], v10, s[8:11], s31 offen sc1
    buffer_load_dwordx4 v[44:47], v11, s[8:11], s31 offen sc1
    s_waitcnt vmcnt(8)
    v_mfma_f32_32x32x16_bf16 v[192:207], v[112:115], v[48:51], v[192:207]
    v_mfma_f32_32x32x16_bf16 v[208:223], v[112:115], v[52:55], v[208:223]
    v_mfma_f32_32x32x16_bf16 v[224:239], v[116:119], v[48:51], v[224:239]
    v_mfma_f32_32x32x16_bf16 v[240:255], v[116:119], v[52:55], v[240:255]
    s_add_u32 s31, s36, 13312
    buffer_load_dwordx4 v[104:107], v10, s[8:11], s31 offen sc1
    buffer_load_dwordx4 v[108:111], v11, s[8:11], s31 offen sc1
    s_waitcnt vmcnt(8)
    v_mfma_f32_32x32x16_bf16 v[192:207], v[120:123], v[56:59], v[192:207]
    v_mfma_f32_32x32x16_bf16 v[208:223], v[120:123], v[60:63], v[208:223]
    v_mfma_f32_32x32x16_bf16 v[224:239], v[124:127], v[56:59], v[224:239]
    v_mfma_f32_32x32x16_bf16 v[240:255], v[124:127], v[60:63], v[240:255]
    s_bitcmp0_b32 s73, 0
    s_cbranch_scc1 B_HF_D4
B_HF_L4:
    buffer_load_dwordx2 v[12:13], v4, s[8:11], s33 offen sc1
    s_cmp_eq_u64 s[74:75], 0
    s_cbranch_scc1 B_HF_W4
    s_mov_b64 exec, s[74:75]
    buffer_load_dword v3, v5, s[8:11], s70 offen sc1
    s_mov_b64 exec, -1
    s_waitcnt vmcnt(1)
    s_branch B_HF_X4
B_HF_W4:
    s_waitcnt vmcnt(0)
B_HF_X4:
    v_cmp_eq_u64 vcc, v[12:13], v[14:15]
    s_nop 0
    s_and_b64 s[74:75], vcc, s[72:73]
    s_andn2_b64 s[72:73], s[72:73], vcc
    s_bitcmp0_b32 s73, 0
    s_cbranch_scc1 B_HF_E4
    s_sub_u32 s39, s39, 1
    s_cbranch_scc1 B_HF_E4
    s_sleep 1
    s_branch B_HF_L4
B_HF_E4:
    s_cmp_eq_u64 s[74:75], 0
    s_cbranch_scc1 B_HF_D4
    s_mov_b64 exec, s[74:75]
    buffer_load_dword v3, v5, s[8:11], s70 offen sc1
    s_mov_b64 exec, -1
    s_mov_b64 s[74:75], 0
B_HF_D4:
    s_add_u32 s31, s36, 16384
    buffer_load_dwordx4 v[48:51], v10, s[8:11], s31 offen sc1
    buffer_load_dwordx4 v[52:55], v11, s[8:11], s31 offen sc1
    s_waitcnt vmcnt(8)
    v_mfma_f32_32x32x16_bf16 v[192:207], v[128:131], v[32:35], v[192:207]
    v_mfma_f32_32x32x16_bf16 v[208:223], v[128:131], v[36:39], v[208:223]
    v_mfma_f32_32x32x16_bf16 v[224:239], v[132:135], v[32:35], v[224:239]
    v_mfma_f32_32x32x16_bf16 v[240:255], v[132:135], v[36:39], v[240:255]
    s_add_u32 s31, s36, 17408
    buffer_load_dwordx4 v[112:115], v10, s[8:11], s31 offen sc1
    buffer_load_dwordx4 v[116:119], v11, s[8:11], s31 offen sc1
    s_waitcnt vmcnt(8)
    v_mfma_f32_32x32x16_bf16 v[192:207], v[136:139], v[96:99], v[192:207]
    v_mfma_f32_32x32x16_bf16 v[208:223], v[136:139], v[100:103], v[208:223]
    v_mfma_f32_32x32x16_bf16 v[224:239], v[140:143], v[96:99], v[224:239]
    v_mfma_f32_32x32x16_bf16 v[240:255], v[140:143], v[100:103], v[240:255]
    s_bitcmp0_b32 s73, 8
    s_cbranch_scc1 B_HF_D5
B_HF_L5:
    buffer_load_dwordx2 v[12:13], v4, s[8:11], s33 offen sc1
    s_cmp_eq_u64 s[74:75], 0
    s_cbranch_scc1 B_HF_W5
    s_mov_b64 exec, s[74:75]
    buffer_load_dword v3, v5, s[8:11], s70 offen sc1
    s_mov_b64 exec, -1
    s_waitcnt vmcnt(1)
    s_branch B_HF_X5
B_HF_W5:
    s_waitcnt vmcnt(0)
B_HF_X5:
    v_cmp_eq_u64 vcc, v[12:13], v[14:15]
    s_nop 0
    s_and_b64 s[74:75], vcc, s[72:73]
    s_andn2_b64 s[72:73], s[72:73], vcc
    s_bitcmp0_b32 s73, 8
    s_cbranch_scc1 B_HF_E5
    s_sub_u32 s39, s39, 1
    s_cbranch_scc1 B_HF_E5
    s_sleep 1
    s_branch B_HF_L5
B_HF_E5:
    s_cmp_eq_u64 s[74:75], 0
    s_cbranch_scc1 B_HF_D5
    s_mov_b64 exec, s[74:75]
    buffer_load_dword v3, v5, s[8:11], s70 offen sc1
    s_mov_b64 exec, -1
    s_mov_b64 s[74:75], 0
B_HF_D5:
    s_add_u32 s31, s36, 20480
    buffer_load_dwordx4 v[56:59], v10, s[8:11], s31 offen sc1
    buffer_load_dwordx4 v[60:63], v11, s[8:11], s31 offen sc1
    s_waitcnt vmcnt(8)
    v_mfma_f32_32x32x16_bf16 v[192:207], v[144:147], v[40:43], v[192:207]
    v_mfma_f32_32x32x16_bf16 v[208:223], v[144:147], v[44:47], v[208:223]
    v_mfma_f32_32x32x16_bf16 v[224:239], v[148:151], v[40:43], v[224:239]
    v_mfma_f32_32x32x16_bf16 v[240:255], v[148:151], v[44:47], v[240:255]
    s_add_u32 s31, s36, 21504
    buffer_load_dwordx4 v[120:123], v10, s[8:11], s31 offen sc1
    buffer_load_dwordx4 v[124:127], v11, s[8:11], s31 offen sc1
    s_waitcnt vmcnt(8)
    v_mfma_f32_32x32x16_bf16 v[192:207], v[152:155], v[104:107], v[192:207]
    v_mfma_f32_32x32x16_bf16 v[208:223], v[152:155], v[108:111], v[208:223]
    v_mfma_f32_32x32x16_bf16 v[224:239], v[156:159], v[104:107], v[224:239]
    v_mfma_f32_32x32x16_bf16 v[240:255], v[156:159], v[108:111], v[240:255]
    s_bitcmp0_b32 s73, 16
    s_cbranch_scc1 B_HF_D6
B_HF_L6:
    buffer_load_dwordx2 v[12:13], v4, s[8:11], s33 offen sc1
    s_cmp_eq_u64 s[74:75], 0
    s_cbranch_scc1 B_HF_W6
    s_mov_b64 exec, s[74:75]
    buffer_load_dword v3, v5, s[8:11], s70 offen sc1
    s_mov_b64 exec, -1
    s_waitcnt vmcnt(1)
    s_branch B_HF_X6
B_HF_W6:
    s_waitcnt vmcnt(0)
B_HF_X6:
    v_cmp_eq_u64 vcc, v[12:13], v[14:15]
    s_nop 0
    s_and_b64 s[74:75], vcc, s[72:73]
    s_andn2_b64 s[72:73], s[72:73], vcc
    s_bitcmp0_b32 s73, 16
    s_cbranch_scc1 B_HF_E6
    s_sub_u32 s39, s39, 1
    s_cbranch_scc1 B_HF_E6
    s_sleep 1
    s_branch B_HF_L6
B_HF_E6:
    s_cmp_eq_u64 s[74:75], 0
    s_cbranch_scc1 B_HF_D6
    s_mov_b64 exec, s[74:75]
    buffer_load_dword v3, v5, s[8:11], s70 offen sc1
    s_mov_b64 exec, -1
    s_mov_b64 s[74:75], 0
B_HF_D6:
    s_add_u32 s31, s36, 24576
    buffer_load_dwordx4 v[32:35], v10, s[8:11], s31 offen sc1
    buffer_load_dwordx4 v[36:39], v11, s[8:11], s31 offen sc1
    s_waitcnt vmcnt(8)
    v_mfma_f32_32x32x16_bf16 v[192:207], v[160:163], v[48:51], v[192:207]
    v_mfma_f32_32x32x16_bf16 v[208:223], v[160:163], v[52:55], v[208:223]
    v_mfma_f32_32x32x16_bf16 v[224:239], v[164:167], v[48:51], v[224:239]
    v_mfma_f32_32x32x16_bf16 v[240:255], v[164:167], v[52:55], v[240:255]
    s_add_u32 s31, s36, 25600
    buffer_load_dwordx4 v[128:131], v10, s[8:11], s31 offen sc1
    buffer_load_dwordx4 v[132:135], v11, s[8:11], s31 offen sc1
    s_waitcnt vmcnt(8)
    v_mfma_f32_32x32x16_bf16 v[192:207], v[168:171], v[112:115], v[192:207]
    v_mfma_f32_32x32x16_bf16 v[208:223], v[168:171], v[116:119], v[208:223]
    v_mfma_f32_32x32x16_bf16 v[224:239], v[172:175], v[112:115], v[224:239]
    v_mfma_f32_32x32x16_bf16 v[240:255], v[172:175], v[116:119], v[240:255]
    s_bitcmp0_b32 s72, 4
    s_cbranch_scc1 B_HF_D7
B_HF_L7:
    buffer_load_dwordx2 v[12:13], v4, s[8:11], s33 offen sc1
    s_cmp_eq_u64 s[74:75], 0
    s_cbranch_scc1 B_HF_W7
    s_mov_b64 exec, s[74:75]
    buffer_load_dword v3, v5, s[8:11], s70 offen sc1
    s_mov_b64 exec, -1
    s_waitcnt vmcnt(1)
    s_branch B_HF_X7
B_HF_W7:
    s_waitcnt vmcnt(0)
B_HF_X7:
    v_cmp_eq_u64 vcc, v[12:13], v[14:15]
    s_nop 0
    s_and_b64 s[74:75], vcc, s[72:73]
    s_andn2_b64 s[72:73], s[72:73], vcc
    s_bitcmp0_b32 s72, 4
    s_cbranch_scc1 B_HF_E7
    s_sub_u32 s39, s39, 1
    s_cbranch_scc1 B_HF_E7
    s_sleep 1
    s_branch B_HF_L7
B_HF_E7:
    s_cmp_eq_u64 s[74:75], 0
    s_cbranch_scc1 B_HF_D7
    s_mov_b64 exec, s[74:75]
    buffer_load_dword v3, v5, s[8:11], s70 offen sc1
    s_mov_b64 exec, -1
    s_mov_b64 s[74:75], 0
B_HF_D7:
    s_add_u32 s31, s36, 2048
    buffer_load_dwordx4 v[96:99], v10, s[8:11], s31 offen sc1
    buffer_load_dwordx4 v[100:103], v11, s[8:11], s31 offen sc1
    s_waitcnt vmcnt(8)
    v_mfma_f32_32x32x16_bf16 v[192:207], v[176:179], v[56:59], v[192:207]
    v_mfma_f32_32x32x16_bf16 v[208:223], v[176:179], v[60:63], v[208:223]
    v_mfma_f32_32x32x16_bf16 v[224:239], v[180:183], v[56:59], v[224:239]
    v_mfma_f32_32x32x16_bf16 v[240:255], v[180:183], v[60:63], v[240:255]
    s_add_u32 s31, s36, 3072
    buffer_load_dwordx4 v[136:139], v10, s[8:11], s31 offen sc1
    buffer_load_dwordx4 v[140:143], v11, s[8:11], s31 offen sc1
    s_waitcnt vmcnt(8)
    v_mfma_f32_32x32x16_bf16 v[192:207], v[184:187], v[120:123], v[192:207]
    v_mfma_f32_32x32x16_bf16 v[208:223], v[184:187], v[124:127], v[208:223]
    v_mfma_f32_32x32x16_bf16 v[224:239], v[188:191], v[120:123], v[224:239]
    v_mfma_f32_32x32x16_bf16 v[240:255], v[188:191], v[124:127], v[240:255]
    s_bitcmp0_b32 s72, 12
    s_cbranch_scc1 B_HF_D8
B_HF_L8:
    buffer_load_dwordx2 v[12:13], v4, s[8:11], s33 offen sc1
    s_cmp_eq_u64 s[74:75], 0
    s_cbranch_scc1 B_HF_W8
    s_mov_b64 exec, s[74:75]
    buffer_load_dword v3, v5, s[8:11], s70 offen sc1
    s_mov_b64 exec, -1
    s_waitcnt vmcnt(1)
    s_branch B_HF_X8
B_HF_W8:
    s_waitcnt vmcnt(0)
B_HF_X8:
    v_cmp_eq_u64 vcc, v[12:13], v[14:15]
    s_nop 0
    s_and_b64 s[74:75], vcc, s[72:73]
    s_andn2_b64 s[72:73], s[72:73], vcc
    s_bitcmp0_b32 s72, 12
    s_cbranch_scc1 B_HF_E8
    s_sub_u32 s39, s39, 1
    s_cbranch_scc1 B_HF_E8
    s_sleep 1
    s_branch B_HF_L8
B_HF_E8:
    s_cmp_eq_u64 s[74:75], 0
    s_cbranch_scc1 B_HF_D8
    s_mov_b64 exec, s[74:75]
    buffer_load_dword v3, v5, s[8:11], s70 offen sc1
    s_mov_b64 exec, -1
    s_mov_b64 s[74:75], 0
B_HF_D8:
    s_add_u32 s31, s36, 6144
    buffer_load_dwordx4 v[40:43], v10, s[8:11], s31 offen sc1
    buffer_load_dwordx4 v[44:47], v11, s[8:11], s31 offen sc1
    s_waitcnt vmcnt(8)
    v_mfma_f32_32x32x16_bf16 v[192:207], v[88:91], v[32:35], v[192:207]
    v_mfma_f32_32x32x16_bf16 v[208:223], v[88:91], v[36:39], v[208:223]
    v_mfma_f32_32x32x16_bf16 v[224:239], v[92:95], v[32:35], v[224:239]
    v_mfma_f32_32x32x16_bf16 v[240:255], v[92:95], v[36:39], v[240:255]
    s_add_u32 s31, s36, 7168
    buffer_load_dwordx4 v[144:147], v10, s[8:11], s31 offen sc1
    buffer_load_dwordx4 v[148:151], v11, s[8:11], s31 offen sc1
    s_waitcnt vmcnt(8)
    v_mfma_f32_32x32x16_bf16 v[192:207], v[80:83], v[128:131], v[192:207]
    v_mfma_f32_32x32x16_bf16 v[208:223], v[80:83], v[132:135], v[208:223]
    v_mfma_f32_32x32x16_bf16 v[224:239], v[84:87], v[128:131], v[224:239]
    v_mfma_f32_32x32x16_bf16 v[240:255], v[84:87], v[132:135], v[240:255]
    s_bitcmp0_b32 s72, 20
    s_cbranch_scc1 B_HF_D9
B_HF_L9:
    buffer_load_dwordx2 v[12:13], v4, s[8:11], s33 offen sc1
    s_cmp_eq_u64 s[74:75], 0
    s_cbranch_scc1 B_HF_W9
    s_mov_b64 exec, s[74:75]
    buffer_load_dword v3, v5, s[8:11], s70 offen sc1
    s_mov_b64 exec, -1
    s_waitcnt vmcnt(1)
    s_branch B_HF_X9
B_HF_W9:
    s_waitcnt vmcnt(0)
B_HF_X9:
    v_cmp_eq_u64 vcc, v[12:13], v[14:15]
    s_nop 0
    s_and_b64 s[74:75], vcc, s[72:73]
    s_andn2_b64 s[72:73], s[72:73], vcc
    s_bitcmp0_b32 s72, 20
    s_cbranch_scc1 B_HF_E9
    s_sub_u32 s39, s39, 1
    s_cbranch_scc1 B_HF_E9
    s_sleep 1
    s_branch B_HF_L9
B_HF_E9:
    s_cmp_eq_u64 s[74:75], 0
    s_cbranch_scc1 B_HF_D9
    s_mov_b64 exec, s[74:75]
    buffer_load_dword v3, v5, s[8:11], s70 offen sc1
    s_mov_b64 exec, -1
    s_mov_b64 s[74:75], 0
B_HF_D9:
    s_add_u32 s31, s36, 10240
    buffer_load_dwordx4 v[104:107], v10, s[8:11], s31 offen sc1
    buffer_load_dwordx4 v[108:111], v11, s[8:11], s31 offen sc1
    s_waitcnt vmcnt(8)
    v_mfma_f32_32x32x16_bf16 v[192:207], v[72:75], v[96:99], v[192:207]
    v_mfma_f32_32x32x16_bf16 v[208:223], v[72:75], v[100:103], v[208:223]
    v_mfma_f32_32x32x16_bf16 v[224:239], v[76:79], v[96:99], v[224:239]
    v_mfma_f32_32x32x16_bf16 v[240:255], v[76:79], v[100:103], v[240:255]
    s_add_u32 s31, s36, 11264
    buffer_load_dwordx4 v[152:155], v10, s[8:11], s31 offen sc1
    buffer_load_dwordx4 v[156:159], v11, s[8:11], s31 offen sc1
    ds_read_b64_tr_b16 v[16:17], v6 offset:8192
    ds_read_b64_tr_b16 v[18:19], v6 offset:9216
    ds_read_b64_tr_b16 v[20:21], v7 offset:8192
    ds_read_b64_tr_b16 v[22:23], v7 offset:9216
    s_waitcnt vmcnt(8)
    v_mfma_f32_32x32x16_bf16 v[192:207], v[64:67], v[136:139], v[192:207]
    v_mfma_f32_32x32x16_bf16 v[208:223], v[64:67], v[140:143], v[208:223]
    v_mfma_f32_32x32x16_bf16 v[224:239], v[68:71], v[136:139], v[224:239]
    v_mfma_f32_32x32x16_bf16 v[240:255], v[68:71], v[140:143], v[240:255]
    s_bitcmp0_b32 s72, 28
    s_cbranch_scc1 B_HF_D10
B_HF_L10:
    buffer_load_dwordx2 v[12:13], v4, s[8:11], s33 offen sc1
    s_cmp_eq_u64 s[74:75], 0
    s_cbranch_scc1 B_HF_W10
    s_mov_b64 exec, s[74:75]
    buffer_load_dword v3, v5, s[8:11], s70 offen sc1
    s_mov_b64 exec, -1
    s_waitcnt vmcnt(1)
    s_branch B_HF_X10
B_HF_W10:
    s_waitcnt vmcnt(0)
B_HF_X10:
    v_cmp_eq_u64 vcc, v[12:13], v[14:15]
    s_nop 0
    s_and_b64 s[74:75], vcc, s[72:73]
    s_andn2_b64 s[72:73], s[72:73], vcc
    s_bitcmp0_b32 s72, 28
    s_cbranch_scc1 B_HF_E10
    s_sub_u32 s39, s39, 1
    s_cbranch_scc1 B_HF_E10
    s_sleep 1
    s_branch B_HF_L10
B_HF_E10:
    s_cmp_eq_u64 s[74:75], 0
    s_cbranch_scc1 B_HF_D10
    s_mov_b64 exec, s[74:75]
    buffer_load_dword v3, v5, s[8:11], s70 offen sc1
    s_mov_b64 exec, -1
    s_mov_b64 s[74:75], 0
B_HF_D10:
    s_add_u32 s31, s36, 14336
    buffer_load_dwordx4 v[48:51], v10, s[8:11], s31 offen sc1
    buffer_load_dwordx4 v[52:55], v11, s[8:11], s31 offen sc1
    s_waitcnt lgkmcnt(0)
    ds_read_b64_tr_b16 v[24:25], v6 offset:10240
    ds_read_b64_tr_b16 v[26:27], v6 offset:11264
    ds_read_b64_tr_b16 v[28:29], v7 offset:10240
    ds_read_b64_tr_b16 v[30:31], v7 offset:11264
    s_waitcnt vmcnt(8)
    v_mfma_f32_32x32x16_bf16 v[192:207], v[16:19], v[40:43], v[192:207]
    v_mfma_f32_32x32x16_bf16 v[208:223], v[16:19], v[44:47], v[208:223]
    v_mfma_f32_32x32x16_bf16 v[224:239], v[20:23], v[40:43], v[224:239]
    v_mfma_f32_32x32x16_bf16 v[240:255], v[20:23], v[44:47], v[240:255]
    s_add_u32 s31, s36, 15360
    buffer_load_dwordx4 v[160:163], v10, s[8:11], s31 offen sc1
    buffer_load_dwordx4 v[164:167], v11, s[8:11], s31 offen sc1
    s_waitcnt lgkmcnt(0)
    ds_read_b64_tr_b16 v[16:17], v8 offset:0
    ds_read_b64_tr_b16 v[18:19], v8 offset:1024
    ds_read_b64_tr_b16 v[20:21], v9 offset:0
    ds_read_b64_tr_b16 v[22:23], v9 offset:1024
    s_waitcnt vmcnt(8)
    v_mfma_f32_32x32x16_bf16 v[192:207], v[24:27], v[144:147], v[192:207]
    v_mfma_f32_32x32x16_bf16 v[208:223], v[24:27], v[148:151], v[208:223]
    v_mfma_f32_32x32x16_bf16 v[224:239], v[28:31], v[144:147], v[224:239]
    v_mfma_f32_32x32x16_bf16 v[240:255], v[28:31], v[148:151], v[240:255]
    s_bitcmp0_b32 s73, 4
    s_cbranch_scc1 B_HF_D11
B_HF_L11:
    buffer_load_dwordx2 v[12:13], v4, s[8:11], s33 offen sc1
    s_cmp_eq_u64 s[74:75], 0
    s_cbranch_scc1 B_HF_W11
    s_mov_b64 exec, s[74:75]
    buffer_load_dword v3, v5, s[8:11], s70 offen sc1
    s_mov_b64 exec, -1
    s_waitcnt vmcnt(1)
    s_branch B_HF_X11
B_HF_W11:
    s_waitcnt vmcnt(0)
B_HF_X11:
    v_cmp_eq_u64 vcc, v[12:13], v[14:15]
    s_nop 0
    s_and_b64 s[74:75], vcc, s[72:73]
    s_andn2_b64 s[72:73], s[72:73], vcc
    s_bitcmp0_b32 s73, 4
    s_cbranch_scc1 B_HF_E11
    s_sub_u32 s39, s39, 1
    s_cbranch_scc1 B_HF_E11
    s_sleep 1
    s_branch B_HF_L11
B_HF_E11:
    s_cmp_eq_u64 s[74:75], 0
    s_cbranch_scc1 B_HF_D11
    s_mov_b64 exec, s[74:75]
    buffer_load_dword v3, v5, s[8:11], s70 offen sc1
    s_mov_b64 exec, -1
    s_mov_b64 s[74:75], 0
B_HF_D11:
    s_add_u32 s31, s36, 18432
    buffer_load_dwordx4 v[112:115], v10, s[8:11], s31 offen sc1
    buffer_load_dwordx4 v[116:119], v11, s[8:11], s31 offen sc1
    s_waitcnt lgkmcnt(0)
    ds_read_b64_tr_b16 v[24:25], v8 offset:2048
    ds_read_b64_tr_b16 v[26:27], v8 offset:3072
    ds_read_b64_tr_b16 v[28:29], v9 offset:2048
    ds_read_b64_tr_b16 v[30:31], v9 offset:3072
    s_waitcnt vmcnt(8)
    v_mfma_f32_32x32x16_bf16 v[192:207], v[16:19], v[104:107], v[192:207]
    v_mfma_f32_32x32x16_bf16 v[208:223], v[16:19], v[108:111], v[208:223]
    v_mfma_f32_32x32x16_bf16 v[224:239], v[20:23], v[104:107], v[224:239]
    v_mfma_f32_32x32x16_bf16 v[240:255], v[20:23], v[108:111], v[240:255]
    s_add_u32 s31, s36, 19456
    buffer_load_dwordx4 v[168:171], v10, s[8:11], s31 offen sc1
    buffer_load_dwordx4 v[172:175], v11, s[8:11], s31 offen sc1
    s_waitcnt lgkmcnt(0)
    ds_read_b64_tr_b16 v[16:17], v8 offset:4096
    ds_read_b64_tr_b16 v[18:19], v8 offset:5120
    ds_read_b64_tr_b16 v[20:21], v9 offset:4096
    ds_read_b64_tr_b16 v[22:23], v9 offset:5120
    s_waitcnt vmcnt(8)
    v_mfma_f32_32x32x16_bf16 v[192:207], v[24:27], v[152:155], v[192:207]
    v_mfma_f32_32x32x16_bf16 v[208:223], v[24:27], v[156:159], v[208:223]
    v_mfma_f32_32x32x16_bf16 v[224:239], v[28:31], v[152:155], v[224:239]
    v_mfma_f32_32x32x16_bf16 v[240:255], v[28:31], v[156:159], v[240:255]
    s_bitcmp0_b32 s73, 12
    s_cbranch_scc1 B_HF_D12
B_HF_L12:
    buffer_load_dwordx2 v[12:13], v4, s[8:11], s33 offen sc1
    s_cmp_eq_u64 s[74:75], 0
    s_cbranch_scc1 B_HF_W12
    s_mov_b64 exec, s[74:75]
    buffer_load_dword v3, v5, s[8:11], s70 offen sc1
    s_mov_b64 exec, -1
    s_waitcnt vmcnt(1)
    s_branch B_HF_X12
B_HF_W12:
    s_waitcnt vmcnt(0)
B_HF_X12:
    v_cmp_eq_u64 vcc, v[12:13], v[14:15]
    s_nop 0
    s_and_b64 s[74:75], vcc, s[72:73]
    s_andn2_b64 s[72:73], s[72:73], vcc
    s_bitcmp0_b32 s73, 12
    s_cbranch_scc1 B_HF_E12
    s_sub_u32 s39, s39, 1
    s_cbranch_scc1 B_HF_E12
    s_sleep 1
    s_branch B_HF_L12
B_HF_E12:
    s_cmp_eq_u64 s[74:75], 0
    s_cbranch_scc1 B_HF_D12
    s_mov_b64 exec, s[74:75]
    buffer_load_dword v3, v5, s[8:11], s70 offen sc1
    s_mov_b64 exec, -1
    s_mov_b64 s[74:75], 0
B_HF_D12:
    s_add_u32 s31, s36, 22528
    buffer_load_dwordx4 v[56:59], v10, s[8:11], s31 offen sc1
    buffer_load_dwordx4 v[60:63], v11, s[8:11], s31 offen sc1
    s_waitcnt lgkmcnt(0)
    ds_read_b64_tr_b16 v[24:25], v8 offset:6144
    ds_read_b64_tr_b16 v[26:27], v8 offset:7168
    ds_read_b64_tr_b16 v[28:29], v9 offset:6144
    ds_read_b64_tr_b16 v[30:31], v9 offset:7168
    s_waitcnt vmcnt(8)
    v_mfma_f32_32x32x16_bf16 v[192:207], v[16:19], v[48:51], v[192:207]
    v_mfma_f32_32x32x16_bf16 v[208:223], v[16:19], v[52:55], v[208:223]
    v_mfma_f32_32x32x16_bf16 v[224:239], v[20:23], v[48:51], v[224:239]
    v_mfma_f32_32x32x16_bf16 v[240:255], v[20:23], v[52:55], v[240:255]
    s_add_u32 s31, s36, 23552
    buffer_load_dwordx4 v[176:179], v10, s[8:11], s31 offen sc1
    buffer_load_dwordx4 v[180:183], v11, s[8:11], s31 offen sc1
    s_waitcnt lgkmcnt(0)
    ds_read_b64_tr_b16 v[16:17], v8 offset:8192
    ds_read_b64_tr_b16 v[18:19], v8 offset:9216
    ds_read_b64_tr_b16 v[20:21], v9 offset:8192
    ds_read_b64_tr_b16 v[22:23], v9 offset:9216
    s_waitcnt vmcnt(8)
    v_mfma_f32_32x32x16_bf16 v[192:207], v[24:27], v[160:163], v[192:207]
    v_mfma_f32_32x32x16_bf16 v[208:223], v[24:27], v[164:167], v[208:223]
    v_mfma_f32_32x32x16_bf16 v[224:239], v[28:31], v[160:163], v[224:239]
    v_mfma_f32_32x32x16_bf16 v[240:255], v[28:31], v[164:167], v[240:255]
    s_bitcmp0_b32 s73, 20
    s_cbranch_scc1 B_HF_D13
B_HF_L13:
    buffer_load_dwordx2 v[12:13], v4, s[8:11], s33 offen sc1
    s_cmp_eq_u64 s[74:75], 0
    s_cbranch_scc1 B_HF_W13
    s_mov_b64 exec, s[74:75]
    buffer_load_dword v3, v5, s[8:11], s70 offen sc1
    s_mov_b64 exec, -1
    s_waitcnt vmcnt(1)
    s_branch B_HF_X13
B_HF_W13:
    s_waitcnt vmcnt(0)
B_HF_X13:
    v_cmp_eq_u64 vcc, v[12:13], v[14:15]
    s_nop 0
    s_and_b64 s[74:75], vcc, s[72:73]
    s_andn2_b64 s[72:73], s[72:73], vcc
    s_bitcmp0_b32 s73, 20
    s_cbranch_scc1 B_HF_E13
    s_sub_u32 s39, s39, 1
    s_cbranch_scc1 B_HF_E13
    s_sleep 1
    s_branch B_HF_L13
B_HF_E13:
    s_cmp_eq_u64 s[74:75], 0
    s_cbranch_scc1 B_HF_D13
    s_mov_b64 exec, s[74:75]
    buffer_load_dword v3, v5, s[8:11], s70 offen sc1
    s_mov_b64 exec, -1
    s_mov_b64 s[74:75], 0
B_HF_D13:
    s_add_u32 s31, s36, 26624
    buffer_load_dwordx4 v[120:123], v10, s[8:11], s31 offen sc1
    buffer_load_dwordx4 v[124:127], v11, s[8:11], s31 offen sc1
    s_waitcnt lgkmcnt(0)
    ds_read_b64_tr_b16 v[24:25], v8 offset:10240
    ds_read_b64_tr_b16 v[26:27], v8 offset:11264
    ds_read_b64_tr_b16 v[28:29], v9 offset:10240
    ds_read_b64_tr_b16 v[30:31], v9 offset:11264
    s_waitcnt vmcnt(8)
    v_mfma_f32_32x32x16_bf16 v[192:207], v[16:19], v[112:115], v[192:207]
    v_mfma_f32_32x32x16_bf16 v[208:223], v[16:19], v[116:119], v[208:223]
    v_mfma_f32_32x32x16_bf16 v[224:239], v[20:23], v[112:115], v[224:239]
    v_mfma_f32_32x32x16_bf16 v[240:255], v[20:23], v[116:119], v[240:255]
    s_add_u32 s31, s36, 27648
    buffer_load_dwordx4 v[184:187], v10, s[8:11], s31 offen sc1
    buffer_load_dwordx4 v[188:191], v11, s[8:11], s31 offen sc1
    s_waitcnt lgkmcnt(0)
    ds_read_b64_tr_b16 v[16:17], v6 offset:0
    ds_read_b64_tr_b16 v[18:19], v6 offset:1024
    ds_read_b64_tr_b16 v[20:21], v7 offset:0
    ds_read_b64_tr_b16 v[22:23], v7 offset:1024
    s_waitcnt vmcnt(8)
    v_mfma_f32_32x32x16_bf16 v[192:207], v[24:27], v[168:171], v[192:207]
    v_mfma_f32_32x32x16_bf16 v[208:223], v[24:27], v[172:175], v[208:223]
    v_mfma_f32_32x32x16_bf16 v[224:239], v[28:31], v[168:171], v[224:239]
    v_mfma_f32_32x32x16_bf16 v[240:255], v[28:31], v[172:175], v[240:255]
    v_bfe_u32 v32, v0, 4, 4
    v_and_b32 v33, 15, v0
    v_lshlrev_b32 v34, 12, v32
    v_lshl_add_u32 v34, v33, 3, v34
    v_lshlrev_b32 v35, 14, v33
    v_lshl_add_u32 v35, v32, 3, v35
    v_lshrrev_b32 v36, 1, v1
    v_lshlrev_b32 v36, 7, v36
    v_and_b32 v37, 1, v1
    v_lshl_add_u32 v36, v37, 4, v36
    s_lshl_b32 s37, s27, 12
    s_lshr_b32 s30, s26, 4
    s_lshl_b32 s30, s30, 3
    s_add_u32 s37, s37, s30
    s_add_u32 s37, s37, 524288
    s_lshl_b32 s71, s26, 16
    s_lshl_b32 s30, s27, 7
    s_add_u32 s71, s71, s30
    buffer_load_dwordx2 v[12:13], v36, s[8:11], s37 offen sc1
    buffer_load_dwordx2 v[168:169], v34, s[4:7], s71 offen offset:0
    buffer_load_dwordx2 v[170:171], v34, s[4:7], s71 offen offset:1024
    buffer_load_dwordx2 v[172:173], v34, s[4:7], s71 offen offset:2048
    buffer_load_dwordx2 v[174:175], v34, s[4:7], s71 offen offset:3072
    s_waitcnt lgkmcnt(0)
    ds_read_b64_tr_b16 v[24:25], v6 offset:2048
    ds_read_b64_tr_b16 v[26:27], v6 offset:3072
    ds_read_b64_tr_b16 v[28:29], v7 offset:2048
    ds_read_b64_tr_b16 v[30:31], v7 offset:3072
    s_waitcnt vmcnt(11)
    v_mfma_f32_32x32x16_bf16 v[192:207], v[16:19], v[56:59], v[192:207]
    v_mfma_f32_32x32x16_bf16 v[208:223], v[16:19], v[60:63], v[208:223]
    v_mfma_f32_32x32x16_bf16 v[224:239], v[20:23], v[56:59], v[224:239]
    v_mfma_f32_32x32x16_bf16 v[240:255], v[20:23], v[60:63], v[240:255]
    s_waitcnt lgkmcnt(0)
    ds_read_b64_tr_b16 v[16:17], v6 offset:4096
    ds_read_b64_tr_b16 v[18:19], v6 offset:5120
    ds_read_b64_tr_b16 v[20:21], v7 offset:4096
    ds_read_b64_tr_b16 v[22:23], v7 offset:5120
    s_waitcnt vmcnt(9)
    v_mfma_f32_32x32x16_bf16 v[192:207], v[24:27], v[176:179], v[192:207]
    v_mfma_f32_32x32x16_bf16 v[208:223], v[24:27], v[180:183], v[208:223]
    v_mfma_f32_32x32x16_bf16 v[224:239], v[28:31], v[176:179], v[224:239]
    v_mfma_f32_32x32x16_bf16 v[240:255], v[28:31], v[180:183], v[240:255]
    s_waitcnt lgkmcnt(0)
    ds_read_b64_tr_b16 v[24:25], v6 offset:6144
    ds_read_b64_tr_b16 v[26:27], v6 offset:7168
    ds_read_b64_tr_b16 v[28:29], v7 offset:6144
    ds_read_b64_tr_b16 v[30:31], v7 offset:7168
    s_waitcnt vmcnt(7)
    v_mfma_f32_32x32x16_bf16 v[192:207], v[16:19], v[120:123], v[192:207]
    v_mfma_f32_32x32x16_bf16 v[208:223], v[16:19], v[124:127], v[208:223]
    v_mfma_f32_32x32x16_bf16 v[224:239], v[20:23], v[120:123], v[224:239]
    v_mfma_f32_32x32x16_bf16 v[240:255], v[20:23], v[124:127], v[240:255]
    s_waitcnt lgkmcnt(0)
    s_waitcnt vmcnt(5)
    v_mfma_f32_32x32x16_bf16 v[192:207], v[24:27], v[184:187], v[192:207]
    v_mfma_f32_32x32x16_bf16 v[208:223], v[24:27], v[188:191], v[208:223]
    v_mfma_f32_32x32x16_bf16 v[224:239], v[28:31], v[184:187], v[224:239]
    v_mfma_f32_32x32x16_bf16 v[240:255], v[28:31], v[188:191], v[240:255]
    s_waitcnt vmcnt(4)
    v_cmp_ne_u64 s[68:69], v[12:13], v[14:15]
    s_lshl_b32 s31, s27, 18
    s_lshl_b32 s30, s26, 7
    s_add_u32 s31, s31, s30
    s_add_u32 s31, s31, 12582912
    buffer_load_dwordx2 v[112:113], v35, s[8:11], s31 offen sc1
    s_add_u32 s31, s31, 4096
    buffer_load_dwordx2 v[114:115], v35, s[8:11], s31 offen sc1
    s_add_u32 s31, s31, 4096
    buffer_load_dwordx2 v[116:117], v35, s[8:11], s31 offen sc1
    s_add_u32 s31, s31, 4096
    buffer_load_dwordx2 v[118:119], v35, s[8:11], s31 offen sc1
    s_add_u32 s31, s31, 4096
    v_and_b32 v3, 31, v1
    v_mul_u32_u24 v3, 272, v3
    v_lshrrev_b32 v8, 5, v1
    v_lshl_add_u32 v3, v8, 4, v3
    v_add_u32 v4, s34, v3
    v_add_u32 v3, s35, v3
    ds_write_b128 v3, v[192:195] offset:0
    ds_write_b128 v3, v[196:199] offset:32
    ds_write_b128 v3, v[200:203] offset:64
    ds_write_b128 v3, v[204:207] offset:96
    ds_write_b128 v4, v[208:211] offset:0
    ds_write_b128 v4, v[212:215] offset:32
    ds_write_b128 v4, v[216:219] offset:64
    ds_write_b128 v4, v[220:223] offset:96
    ds_write_b128 v3, v[224:227] offset:128
    ds_write_b128 v3, v[228:231] offset:160
    ds_write_b128 v3, v[232:235] offset:192
    ds_write_b128 v3, v[236:239] offset:224
    ds_write_b128 v4, v[240:243] offset:128
    ds_write_b128 v4, v[244:247] offset:160
    ds_write_b128 v4, v[248:251] offset:192
    ds_write_b128 v4, v[252:255] offset:224
    s_cmp_eq_u64 s[68:69], 0
    s_cbranch_scc1 B_AF_OK
    s_mov_b32 s39, 1000000
B_AF_L:
    buffer_load_dwordx2 v[12:13], v36, s[8:11], s37 offen sc1
    s_waitcnt vmcnt(0)
    v_cmp_ne_u64 vcc, v[12:13], v[14:15]
    s_cbranch_vccz B_AF_D
    s_sub_u32 s39, s39, 1
    s_cbranch_scc1 B_AF_D
    s_sleep 2
    s_branch B_AF_L
B_AF_D:
    s_lshl_b32 s31, s27, 18
    s_lshl_b32 s30, s26, 7
    s_add_u32 s31, s31, s30
    s_add_u32 s31, s31, 12582912
    buffer_load_dwordx2 v[112:113], v35, s[8:11], s31 offen sc1
    s_add_u32 s31, s31, 4096
    buffer_load_dwordx2 v[114:115], v35, s[8:11], s31 offen sc1
    s_add_u32 s31, s31, 4096
    buffer_load_dwordx2 v[116:117], v35, s[8:11], s31 offen sc1
    s_add_u32 s31, s31, 4096
    buffer_load_dwordx2 v[118:119], v35, s[8:11], s31 offen sc1
    s_add_u32 s31, s31, 4096
B_AF_OK:
    v_and_b32 v3, 7, v32
    v_mul_u32_u24 v3, 1088, v3
    v_lshl_add_u32 v3, v33, 4, v3
    v_lshrrev_b32 v4, 3, v32
    v_mul_u32_u24 v4, 98304, v4
    v_add_u32 v3, v3, v4
    s_waitcnt lgkmcnt(0)
    s_barrier
    ds_read_b128 v[192:195], v3 offset:0
    ds_read_b128 v[196:199], v3 offset:12288
    ds_read_b128 v[200:203], v3 offset:24576
    ds_read_b128 v[204:207], v3 offset:36864
    ds_read_b128 v[208:211], v3 offset:272
    ds_read_b128 v[212:215], v3 offset:12560
    ds_read_b128 v[216:219], v3 offset:24848
    ds_read_b128 v[220:223], v3 offset:37136
    ds_read_b128 v[224:227], v3 offset:544
    ds_read_b128 v[228:231], v3 offset:12832
    ds_read_b128 v[232:235], v3 offset:25120
    ds_read_b128 v[236:239], v3 offset:37408
    ds_read_b128 v[240:243], v3 offset:816
    ds_read_b128 v[244:247], v3 offset:13104
    ds_read_b128 v[248:251], v3 offset:25392
    ds_read_b128 v[252:255], v3 offset:37680
    s_waitcnt vmcnt(0)
    v_lshlrev_b32 v4, 16, v168
    v_lshlrev_b32 v8, 16, v112
    v_and_b32 v5, s38, v168
    v_lshlrev_b32 v9, 16, v114
    v_lshlrev_b32 v6, 16, v169
    v_lshlrev_b32 v10, 16, v116
    v_and_b32 v7, s38, v169
    v_lshlrev_b32 v11, 16, v118
    v_pk_add_f32 v[4:5], v[4:5], v[8:9]
    v_pk_add_f32 v[6:7], v[6:7], v[10:11]
    v_cvt_pk_bf16_f32 v8, v4, v5
    v_cvt_pk_bf16_f32 v9, v6, v7
    v_lshlrev_b32 v16, 16, v8
    v_and_b32 v17, s38, v8
    v_lshlrev_b32 v18, 16, v9
    v_and_b32 v19, s38, v9
    v_lshlrev_b32 v4, 16, v170
    v_and_b32 v8, s38, v112
    v_and_b32 v5, s38, v170
    v_and_b32 v9, s38, v114
    v_lshlrev_b32 v6, 16, v171
    v_and_b32 v10, s38, v116
    v_and_b32 v7, s38, v171
    v_and_b32 v11, s38, v118
    v_pk_add_f32 v[4:5], v[4:5], v[8:9]
    v_pk_add_f32 v[6:7], v[6:7], v[10:11]
    v_cvt_pk_bf16_f32 v8, v4, v5
    v_cvt_pk_bf16_f32 v9, v6, v7
    v_lshlrev_b32 v20, 16, v8
    v_and_b32 v21, s38, v8
    v_lshlrev_b32 v22, 16, v9
    v_and_b32 v23, s38, v9
    v_lshlrev_b32 v4, 16, v172
    v_lshlrev_b32 v8, 16, v113
    v_and_b32 v5, s38, v172
    v_lshlrev_b32 v9, 16, v115
    v_lshlrev_b32 v6, 16, v173
    v_lshlrev_b32 v10, 16, v117
    v_and_b32 v7, s38, v173
    v_lshlrev_b32 v11, 16, v119
    v_pk_add_f32 v[4:5], v[4:5], v[8:9]
    v_pk_add_f32 v[6:7], v[6:7], v[10:11]
    v_cvt_pk_bf16_f32 v8, v4, v5
    v_cvt_pk_bf16_f32 v9, v6, v7
    v_lshlrev_b32 v24, 16, v8
    v_and_b32 v25, s38, v8
    v_lshlrev_b32 v26, 16, v9
    v_and_b32 v27, s38, v9
    v_lshlrev_b32 v4, 16, v174
    v_and_b32 v8, s38, v113
    v_and_b32 v5, s38, v174
    v_and_b32 v9, s38, v115
    v_lshlrev_b32 v6, 16, v175
    v_and_b32 v10, s38, v117
    v_and_b32 v7, s38, v175
    v_and_b32 v11, s38, v119
    v_pk_add_f32 v[4:5], v[4:5], v[8:9]
    v_pk_add_f32 v[6:7], v[6:7], v[10:11]
    v_cvt_pk_bf16_f32 v8, v4, v5
    v_cvt_pk_bf16_f32 v9, v6, v7
    v_lshlrev_b32 v28, 16, v8
    v_and_b32 v29, s38, v8
    v_lshlrev_b32 v30, 16, v9
    v_and_b32 v31, s38, v9
    s_waitcnt lgkmcnt(12)
    v_pk_add_f32 v[192:193], v[192:193], v[196:197]
    v_pk_add_f32 v[200:201], v[200:201], v[204:205]
    v_pk_add_f32 v[194:195], v[194:195], v[198:199]
    v_pk_add_f32 v[202:203], v[202:203], v[206:207]
    v_pk_add_f32 v[192:193], v[192:193], v[200:201]
    v_pk_add_f32 v[194:195], v[194:195], v[202:203]
    v_cvt_pk_bf16_f32 v196, v192, v193
    v_cvt_pk_bf16_f32 v197, v194, v195
    v_lshlrev_b32 v200, 16, v196
    v_and_b32 v201, s38, v196
    v_lshlrev_b32 v202, 16, v197
    v_and_b32 v203, s38, v197
    v_pk_add_f32 v[200:201], v[200:201], v[16:17]
    v_pk_add_f32 v[202:203], v[202:203], v[18:19]
    v_cvt_pk_bf16_f32 v192, v200, v201
    v_cvt_pk_bf16_f32 v193, v202, v203
    buffer_store_dwordx2 v[192:193], v34, s[20:23], s71 offen offset:0 sc1
    s_waitcnt lgkmcnt(8)
    v_pk_add_f32 v[208:209], v[208:209], v[212:213]
    v_pk_add_f32 v[216:217], v[216:217], v[220:221]
    v_pk_add_f32 v[210:211], v[210:211], v[214:215]
    v_pk_add_f32 v[218:219], v[218:219], v[222:223]
    v_pk_add_f32 v[208:209], v[208:209], v[216:217]
    v_pk_add_f32 v[210:211], v[210:211], v[218:219]
    v_cvt_pk_bf16_f32 v212, v208, v209
    v_cvt_pk_bf16_f32 v213, v210, v211
    v_lshlrev_b32 v216, 16, v212
    v_and_b32 v217, s38, v212
    v_lshlrev_b32 v218, 16, v213
    v_and_b32 v219, s38, v213
    v_pk_add_f32 v[216:217], v[216:217], v[20:21]
    v_pk_add_f32 v[218:219], v[218:219], v[22:23]
    v_cvt_pk_bf16_f32 v208, v216, v217
    v_cvt_pk_bf16_f32 v209, v218, v219
    buffer_store_dwordx2 v[208:209], v34, s[20:23], s71 offen offset:1024 sc1
    s_waitcnt lgkmcnt(4)
    v_pk_add_f32 v[224:225], v[224:225], v[228:229]
    v_pk_add_f32 v[232:233], v[232:233], v[236:237]
    v_pk_add_f32 v[226:227], v[226:227], v[230:231]
    v_pk_add_f32 v[234:235], v[234:235], v[238:239]
    v_pk_add_f32 v[224:225], v[224:225], v[232:233]
    v_pk_add_f32 v[226:227], v[226:227], v[234:235]
    v_cvt_pk_bf16_f32 v228, v224, v225
    v_cvt_pk_bf16_f32 v229, v226, v227
    v_lshlrev_b32 v232, 16, v228
    v_and_b32 v233, s38, v228
    v_lshlrev_b32 v234, 16, v229
    v_and_b32 v235, s38, v229
    v_pk_add_f32 v[232:233], v[232:233], v[24:25]
    v_pk_add_f32 v[234:235], v[234:235], v[26:27]
    v_cvt_pk_bf16_f32 v224, v232, v233
    v_cvt_pk_bf16_f32 v225, v234, v235
    buffer_store_dwordx2 v[224:225], v34, s[20:23], s71 offen offset:2048 sc1
    s_waitcnt lgkmcnt(0)
    v_pk_add_f32 v[240:241], v[240:241], v[244:245]
    v_pk_add_f32 v[248:249], v[248:249], v[252:253]
    v_pk_add_f32 v[242:243], v[242:243], v[246:247]
    v_pk_add_f32 v[250:251], v[250:251], v[254:255]
    v_pk_add_f32 v[240:241], v[240:241], v[248:249]
    v_pk_add_f32 v[242:243], v[242:243], v[250:251]
    v_cvt_pk_bf16_f32 v244, v240, v241
    v_cvt_pk_bf16_f32 v245, v242, v243
    v_lshlrev_b32 v248, 16, v244
    v_and_b32 v249, s38, v244
    v_lshlrev_b32 v250, 16, v245
    v_and_b32 v251, s38, v245
    v_pk_add_f32 v[248:249], v[248:249], v[28:29]
    v_pk_add_f32 v[250:251], v[250:251], v[30:31]
    v_cvt_pk_bf16_f32 v240, v248, v249
    v_cvt_pk_bf16_f32 v241, v250, v251
    buffer_store_dwordx2 v[240:241], v34, s[20:23], s71 offen offset:3072 sc1
    s_endpgm
ROLE_A:
    s_mov_b32 s8, s66
    s_mov_b32 s9, s67
    s_mov_b32 s10, 0x1000000
    s_mov_b32 s11, 0x00020000
    s_mov_b32 s38, 0xffff0000
    s_cmp_lg_u32 s2, 255
    s_cbranch_scc1 A_NOZ
    s_cmp_lg_u32 s3, 0
    s_cbranch_scc1 A_NOZ
    v_mov_b32 v3, 0
    s_mov_b32 s31, 32768
    buffer_load_dword v4, v3, s[8:11], s31 offen sc1
    s_waitcnt vmcnt(0)
    v_add_u32 v4, 1, v4
    v_max_u32 v4, 1, v4
    v_cmp_eq_u32 vcc, 0, v1
    s_nop 0
    s_and_saveexec_b64 s[74:75], vcc
    global_store_dword v3, v4, s[64:65] sc1
    buffer_store_dword v4, v3, s[8:11], s31 offen sc1
    s_mov_b64 exec, s[74:75]
    s_waitcnt vmcnt(0)
A_NOZ:
    v_bfe_u32 v3, v1, 4, 1
    v_lshrrev_b32 v12, 5, v1
    v_bfe_u32 v13, v1, 2, 2
    v_and_b32 v15, 3, v1
    v_lshl_add_u32 v12, v12, 3, v13
    v_lshlrev_b32 v12, 7, v12
    v_lshl_add_u32 v12, v3, 13, v12
    v_lshl_add_u32 v12, v15, 3, v12
    v_add_u32 v12, 32768, v12
    v_lshrrev_b32 v13, 1, v13
    v_lshl_add_u32 v13, v3, 1, v13
    v_lshl_add_u32 v20, v13, 5, v12
    v_xor_b32 v21, 32, v20
    v_xor_b32 v22, 64, v20
    v_xor_b32 v23, 96, v20
    v_and_b32 v3, 31, v1
    v_lshrrev_b32 v12, 5, v1
    v_bfe_u32 v13, v3, 1, 3
    v_xor_b32 v13, v12, v13
    v_lshl_add_u32 v3, v2, 6, v3
    v_lshlrev_b32 v3, 7, v3
    v_lshl_add_u32 v24, v13, 4, v3
    v_xor_b32 v25, 32, v24
    v_xor_b32 v26, 64, v24
    v_xor_b32 v27, 96, v24
    v_lshlrev_b32 v48, 2, v1
    v_lshlrev_b32 v49, 12, v2
    v_add_u32 v49, 131072, v49
    v_add_u32 v48, v48, v49
    v_xor_b32 v96, 0, v48
    v_xor_b32 v97, 32, v48
    v_xor_b32 v98, 64, v48
    v_xor_b32 v99, 96, v48
    v_xor_b32 v100, 128, v48
    v_xor_b32 v101, 160, v48
    v_xor_b32 v102, 192, v48
    v_xor_b32 v103, 224, v48
    v_and_b32 v50, 15, v1
    v_lshrrev_b32 v51, 4, v1
    v_and_b32 v52, 7, v50
    v_lshlrev_b32 v52, 2, v52
    v_cmp_lt_u32 vcc, 7, v50
    v_mov_b32 v112, v50
    v_mov_b32 v53, 0x76543210
    v_mov_b32 v54, 0xcbaaa988
    v_cndmask_b32 v53, v53, v54, vcc
    v_lshrrev_b32 v53, v52, v53
    v_and_b32 v113, 15, v53
    v_mov_b32 v53, 0x22111000
    v_mov_b32 v54, 0x55444333
    v_cndmask_b32 v53, v53, v54, vcc
    v_lshrrev_b32 v53, v52, v53
    v_and_b32 v114, 15, v53
    v_mov_b32 v53, 0x98987676
    v_mov_b32 v54, 0xdcdcbaba
    v_cndmask_b32 v53, v53, v54, vcc
    v_lshrrev_b32 v53, v52, v53
    v_and_b32 v115, 15, v53
    v_and_b32 v53, 14, v112
    v_xor_b32 v53, v51, v53
    v_lshlrev_b32 v53, 4, v53
    v_lshl_add_u32 v53, v112, 8, v53
    v_add_u32 v112, v53, v49
    v_xor_b32 v116, 64, v112
    v_xor_b32 v117, 128, v112
    v_xor_b32 v118, 192, v112
    v_and_b32 v53, 14, v113
    v_xor_b32 v53, v51, v53
    v_lshlrev_b32 v53, 4, v53
    v_lshl_add_u32 v53, v113, 8, v53
    v_add_u32 v113, v53, v49
    v_xor_b32 v119, 64, v113
    v_xor_b32 v120, 128, v113
    v_xor_b32 v121, 192, v113
    v_and_b32 v53, 14, v114
    v_xor_b32 v53, v51, v53
    v_lshlrev_b32 v53, 4, v53
    v_lshl_add_u32 v53, v114, 8, v53
    v_add_u32 v114, v53, v49
    v_xor_b32 v122, 64, v114
    v_xor_b32 v123, 128, v114
    v_xor_b32 v124, 192, v114
    v_and_b32 v53, 14, v115
    v_xor_b32 v53, v51, v53
    v_lshlrev_b32 v53, 4, v53
    v_lshl_add_u32 v53, v115, 8, v53
    v_add_u32 v115, v53, v49
    v_xor_b32 v125, 64, v115
    v_xor_b32 v126, 128, v115
    v_xor_b32 v127, 192, v115
    v_and_b32 v18, 31, v1
    v_lshl_add_u32 v18, v2, 6, v18
    v_lshlrev_b32 v18, 3, v18
    v_add_u32 v18, 160768, v18
    v_mov_b32 v19, 163584
    s_waitcnt vmcnt(1)
    v_lshlrev_b32 v40, 16, v40
    v_lshlrev_b32 v41, 16, v41
    v_lshlrev_b32 v42, 16, v42
    v_lshlrev_b32 v43, 16, v43
    v_lshlrev_b32 v44, 16, v44
    v_lshlrev_b32 v45, 16, v45
    v_lshlrev_b32 v46, 16, v46
    v_mul_f32 v48, 0x3fb8aa3b, v46
    s_mov_b32 s30, 0x3fb8aa3b
    v_fma_f32 v49, v46, s30, -v48
    v_fmac_f32 v49, 0x32a57060, v46
    v_exp_f32 v48, v48
    v_mul_f32 v49, 0x3f317218, v49
    v_fma_f32 v46, v48, v49, v48
    v_cvt_pk_bf16_f32 v46, v46, v46
    v_lshlrev_b32 v46, 16, v46
    v_mul_f32 v50, 0x3fb8aa3b, v40
    s_mov_b32 s30, 0x3fb8aa3b
    v_fma_f32 v51, v40, s30, -v50
    v_fmac_f32 v51, 0x32a57060, v40
    v_exp_f32 v50, v50
    v_mul_f32 v51, 0x3f317218, v51
    v_fma_f32 v40, v50, v51, v50
    v_cvt_pk_bf16_f32 v40, v40, v40
    v_lshlrev_b32 v40, 16, v40
    v_mul_f32 v40, v40, v46
    v_mul_f32 v41, v41, v46
    v_max_f32 v48, abs(v42), abs(v43)
    v_max3_f32 v48, abs(v44), abs(v45), v48
    s_nop 1
    v_max_f32_dpp v48, v48, v48 quad_perm:[1,0,3,2] row_mask:0xf bank_mask:0xf
    s_nop 1
    v_max_f32_dpp v48, v48, v48 quad_perm:[2,3,0,1] row_mask:0xf bank_mask:0xf
    s_nop 1
    v_max_f32_dpp v48, v48, v48 row_ror:4 row_mask:0xf bank_mask:0xf
    s_nop 1
    v_max_f32_dpp v48, v48, v48 row_ror:8 row_mask:0xf bank_mask:0xf
    s_nop 0
    v_readlane_b32 s30, v48, 0
    v_readlane_b32 s31, v48, 16
    v_readlane_b32 s71, v48, 32
    v_readlane_b32 s72, v48, 48
    s_max_u32 s30, s30, s31
    s_max_u32 s71, s71, s72
    s_max_u32 s30, s30, s71
    s_and_b32 s30, s30, 0x7f800000
    s_sub_u32 s31, 0x7f000000, s30
    v_mul_f32 v42, s31, v42
    v_mul_f32 v43, s31, v43
    v_mul_f32 v46, s30, v46
    v_add_f32 v46, v46, v46
    v_mul_f32 v48, 0xc138aa3b, v40
    v_mul_f32 v52, 0xc3b8aa3b, v40
    v_mul_f32 v68, 0xbfb8aa3b, v40
    v_exp_f32 v48, v48
    v_exp_f32 v52, v52
    v_exp_f32 v68, v68
    v_mul_f32 v49, 0x41000000, v41
    v_mul_f32 v53, 0x43800000, v41
    v_mul_f32 v69, 0x3f800000, v41
    v_mul_f32 v50, 0x3e22f983, v49
    v_mul_f32 v54, 0x3e22f983, v53
    v_mul_f32 v70, 0x3e22f983, v69
    s_mov_b32 s30, 0x3e22f983
    s_mov_b32 s30, 0x3e22f983
    s_mov_b32 s30, 0x3e22f983
    v_fma_f32 v51, v49, s30, -v50
    v_fma_f32 v55, v53, s30, -v54
    v_fma_f32 v71, v69, s30, -v70
    v_fmac_f32 v51, 0x31dc9c88, v49
    v_fmac_f32 v55, 0x31dc9c88, v53
    v_fmac_f32 v71, 0x31dc9c88, v69
    v_fract_f32 v50, v50
    v_fract_f32 v54, v54
    v_fract_f32 v70, v70
    v_add_f32 v50, v50, v51
    v_add_f32 v54, v54, v55
    v_add_f32 v70, v70, v71
    v_cos_f32 v58, v50
    v_cos_f32 v60, v54
    v_cos_f32 v56, v70
    v_sin_f32 v59, v50
    v_sin_f32 v61, v54
    v_sin_f32 v57, v70
    v_mul_f32 v58, v58, v48
    v_mul_f32 v60, v60, v52
    v_mul_f32 v56, v56, v68
    v_mul_f32 v59, v59, v48
    v_mul_f32 v61, v61, v52
    v_mul_f32 v57, v57, v68
    v_mov_b32 v74, 1.0
    v_mov_b32 v75, 0
    v_cvt_pk_f16_f32 v216, v74, v75
    v_cvt_pk_f16_f32 v217, v58, v59
    v_cvt_pk_f16_f32 v128, v42, -v43
    v_pk_mul_f32 v[66:67], v[58:59], v[58:59] op_sel_hi:[1,0]
    v_pk_mul_f32 v[176:177], v[42:43], v[60:61] op_sel_hi:[1,0]
    v_pk_mul_f32 v[62:63], v[56:57], v[56:57] op_sel_hi:[1,0]
    v_pk_mul_f32 v[72:73], v[60:61], v[60:61] op_sel_hi:[1,0]
    v_pk_mul_f32 v[162:163], v[42:43], v[56:57] op_sel_hi:[1,0]
    ds_write2st64_b32 v96, v216, v217 offset0:0 offset1:1
    v_pk_fma_f32 v[66:67], v[58:59], v[58:59], v[66:67] op_sel:[1,1,0] op_sel_hi:[0,1,1] neg_lo:[1,0,0]
    v_pk_fma_f32 v[176:177], v[42:43], v[60:61], v[176:177] op_sel:[1,1,0] op_sel_hi:[0,1,1] neg_lo:[1,0,0]
    v_pk_fma_f32 v[62:63], v[56:57], v[56:57], v[62:63] op_sel:[1,1,0] op_sel_hi:[0,1,1] neg_lo:[1,0,0]
    v_pk_fma_f32 v[72:73], v[60:61], v[60:61], v[72:73] op_sel:[1,1,0] op_sel_hi:[0,1,1] neg_lo:[1,0,0]
    v_pk_fma_f32 v[162:163], v[42:43], v[56:57], v[162:163] op_sel:[1,1,0] op_sel_hi:[0,1,1] neg_lo:[1,0,0]
    v_pk_mul_f32 v[70:71], v[66:67], v[66:67] op_sel_hi:[1,0]
    v_pk_mul_f32 v[68:69], v[66:67], v[58:59] op_sel_hi:[1,0]
    v_pk_mul_f32 v[64:65], v[62:63], v[62:63] op_sel_hi:[1,0]
    v_pk_mul_f32 v[186:187], v[176:177], v[60:61] op_sel_hi:[1,0]
    v_pk_mul_f32 v[192:193], v[176:177], v[72:73] op_sel_hi:[1,0]
    v_pk_mul_f32 v[164:165], v[42:43], v[62:63] op_sel_hi:[1,0]
    v_cvt_pk_f16_f32 v218, v66, v67
    v_cvt_pk_f16_f32 v136, v176, -v177
    v_cvt_pk_f16_f32 v129, v162, -v163
    v_pk_fma_f32 v[70:71], v[66:67], v[66:67], v[70:71] op_sel:[1,1,0] op_sel_hi:[0,1,1] neg_lo:[1,0,0]
    v_pk_fma_f32 v[68:69], v[66:67], v[58:59], v[68:69] op_sel:[1,1,0] op_sel_hi:[0,1,1] neg_lo:[1,0,0]
    v_pk_fma_f32 v[64:65], v[62:63], v[62:63], v[64:65] op_sel:[1,1,0] op_sel_hi:[0,1,1] neg_lo:[1,0,0]
    v_pk_fma_f32 v[186:187], v[176:177], v[60:61], v[186:187] op_sel:[1,1,0] op_sel_hi:[0,1,1] neg_lo:[1,0,0]
    v_pk_fma_f32 v[192:193], v[176:177], v[72:73], v[192:193] op_sel:[1,1,0] op_sel_hi:[0,1,1] neg_lo:[1,0,0]
    v_pk_fma_f32 v[164:165], v[42:43], v[62:63], v[164:165] op_sel:[1,1,0] op_sel_hi:[0,1,1] neg_lo:[1,0,0]
    v_pk_mul_f32 v[82:83], v[58:59], v[70:71] op_sel_hi:[1,0]
    v_pk_mul_f32 v[86:87], v[66:67], v[70:71] op_sel_hi:[1,0]
    v_pk_mul_f32 v[90:91], v[68:69], v[70:71] op_sel_hi:[1,0]
    v_pk_mul_f32 v[198:199], v[186:187], v[72:73] op_sel_hi:[1,0]
    v_pk_mul_f32 v[202:203], v[192:193], v[72:73] op_sel_hi:[1,0]
    v_pk_mul_f32 v[166:167], v[162:163], v[62:63] op_sel_hi:[1,0]
    v_cvt_pk_f16_f32 v220, v70, v71
    v_cvt_pk_f16_f32 v219, v68, v69
    v_cvt_pk_f16_f32 v141, v186, -v187
    v_cvt_pk_f16_f32 v144, v192, -v193
    v_cvt_pk_f16_f32 v130, v164, -v165
    ds_write2st64_b32 v97, v218, v219 offset0:2 offset1:3
    v_pk_fma_f32 v[82:83], v[58:59], v[70:71], v[82:83] op_sel:[1,1,0] op_sel_hi:[0,1,1] neg_lo:[1,0,0]
    v_pk_fma_f32 v[86:87], v[66:67], v[70:71], v[86:87] op_sel:[1,1,0] op_sel_hi:[0,1,1] neg_lo:[1,0,0]
    v_pk_fma_f32 v[90:91], v[68:69], v[70:71], v[90:91] op_sel:[1,1,0] op_sel_hi:[0,1,1] neg_lo:[1,0,0]
    v_pk_fma_f32 v[198:199], v[186:187], v[72:73], v[198:199] op_sel:[1,1,0] op_sel_hi:[0,1,1] neg_lo:[1,0,0]
    v_pk_fma_f32 v[202:203], v[192:193], v[72:73], v[202:203] op_sel:[1,1,0] op_sel_hi:[0,1,1] neg_lo:[1,0,0]
    v_pk_fma_f32 v[166:167], v[162:163], v[62:63], v[166:167] op_sel:[1,1,0] op_sel_hi:[0,1,1] neg_lo:[1,0,0]
    v_pk_mul_f32 v[76:77], v[70:71], v[70:71] op_sel_hi:[1,0]
    v_pk_mul_f32 v[80:81], v[82:83], v[70:71] op_sel_hi:[1,0]
    v_pk_mul_f32 v[84:85], v[86:87], v[70:71] op_sel_hi:[1,0]
    v_pk_mul_f32 v[88:89], v[90:91], v[70:71] op_sel_hi:[1,0]
    v_pk_mul_f32 v[168:169], v[42:43], v[64:65] op_sel_hi:[1,0]
    v_pk_mul_f32 v[170:171], v[162:163], v[64:65] op_sel_hi:[1,0]
    v_pk_mul_f32 v[172:173], v[164:165], v[64:65] op_sel_hi:[1,0]
    v_cvt_pk_f16_f32 v221, v82, v83
    v_cvt_pk_f16_f32 v222, v86, v87
    v_cvt_pk_f16_f32 v223, v90, v91
    v_cvt_pk_f16_f32 v147, v198, -v199
    v_cvt_pk_f16_f32 v149, v202, -v203
    v_cvt_pk_f16_f32 v131, v166, -v167
    ds_write2st64_b32 v98, v220, v221 offset0:4 offset1:5
    ds_write2st64_b32 v99, v222, v223 offset0:6 offset1:7
    v_pk_fma_f32 v[76:77], v[70:71], v[70:71], v[76:77] op_sel:[1,1,0] op_sel_hi:[0,1,1] neg_lo:[1,0,0]
    v_pk_fma_f32 v[80:81], v[82:83], v[70:71], v[80:81] op_sel:[1,1,0] op_sel_hi:[0,1,1] neg_lo:[1,0,0]
    v_pk_fma_f32 v[84:85], v[86:87], v[70:71], v[84:85] op_sel:[1,1,0] op_sel_hi:[0,1,1] neg_lo:[1,0,0]
    v_pk_fma_f32 v[88:89], v[90:91], v[70:71], v[88:89] op_sel:[1,1,0] op_sel_hi:[0,1,1] neg_lo:[1,0,0]
    v_pk_fma_f32 v[168:169], v[42:43], v[64:65], v[168:169] op_sel:[1,1,0] op_sel_hi:[0,1,1] neg_lo:[1,0,0]
    v_pk_fma_f32 v[170:171], v[162:163], v[64:65], v[170:171] op_sel:[1,1,0] op_sel_hi:[0,1,1] neg_lo:[1,0,0]
    v_pk_fma_f32 v[172:173], v[164:165], v[64:65], v[172:173] op_sel:[1,1,0] op_sel_hi:[0,1,1] neg_lo:[1,0,0]
    v_pk_mul_f32 v[78:79], v[76:77], v[70:71] op_sel_hi:[1,0]
    v_pk_mul_f32 v[82:83], v[80:81], v[70:71] op_sel_hi:[1,0]
    v_pk_mul_f32 v[86:87], v[84:85], v[70:71] op_sel_hi:[1,0]
    v_pk_mul_f32 v[90:91], v[88:89], v[70:71] op_sel_hi:[1,0]
    v_pk_mul_f32 v[206:207], v[198:199], v[72:73] op_sel_hi:[1,0]
    v_pk_mul_f32 v[210:211], v[202:203], v[72:73] op_sel_hi:[1,0]
    v_pk_mul_f32 v[174:175], v[166:167], v[64:65] op_sel_hi:[1,0]
    v_cvt_pk_f16_f32 v224, v76, v77
    v_cvt_pk_f16_f32 v225, v80, v81
    v_cvt_pk_f16_f32 v226, v84, v85
    v_cvt_pk_f16_f32 v227, v88, v89
    v_cvt_pk_f16_f32 v132, v168, -v169
    v_cvt_pk_f16_f32 v133, v170, -v171
    v_cvt_pk_f16_f32 v134, v172, -v173
    ds_write2st64_b32 v100, v224, v225 offset0:8 offset1:9
    ds_write2st64_b32 v101, v226, v227 offset0:10 offset1:11
    v_pk_fma_f32 v[78:79], v[76:77], v[70:71], v[78:79] op_sel:[1,1,0] op_sel_hi:[0,1,1] neg_lo:[1,0,0]
    v_pk_fma_f32 v[82:83], v[80:81], v[70:71], v[82:83] op_sel:[1,1,0] op_sel_hi:[0,1,1] neg_lo:[1,0,0]
    v_pk_fma_f32 v[86:87], v[84:85], v[70:71], v[86:87] op_sel:[1,1,0] op_sel_hi:[0,1,1] neg_lo:[1,0,0]
    v_pk_fma_f32 v[90:91], v[88:89], v[70:71], v[90:91] op_sel:[1,1,0] op_sel_hi:[0,1,1] neg_lo:[1,0,0]
    v_pk_fma_f32 v[206:207], v[198:199], v[72:73], v[206:207] op_sel:[1,1,0] op_sel_hi:[0,1,1] neg_lo:[1,0,0]
    v_pk_fma_f32 v[210:211], v[202:203], v[72:73], v[210:211] op_sel:[1,1,0] op_sel_hi:[0,1,1] neg_lo:[1,0,0]
    v_pk_fma_f32 v[174:175], v[166:167], v[64:65], v[174:175] op_sel:[1,1,0] op_sel_hi:[0,1,1] neg_lo:[1,0,0]
    v_pk_mul_f32 v[76:77], v[78:79], v[70:71] op_sel_hi:[1,0]
    v_pk_mul_f32 v[80:81], v[82:83], v[70:71] op_sel_hi:[1,0]
    v_pk_mul_f32 v[84:85], v[86:87], v[70:71] op_sel_hi:[1,0]
    v_pk_mul_f32 v[88:89], v[90:91], v[70:71] op_sel_hi:[1,0]
    v_pk_mul_f32 v[178:179], v[176:177], v[62:63] op_sel_hi:[1,0]
    v_pk_mul_f32 v[180:181], v[176:177], v[64:65] op_sel_hi:[1,0]
    v_pk_mul_f32 v[184:185], v[176:177], v[58:59] op_sel_hi:[1,0]
    v_cvt_pk_f16_f32 v228, v78, v79
    v_cvt_pk_f16_f32 v229, v82, v83
    v_cvt_pk_f16_f32 v230, v86, v87
    v_cvt_pk_f16_f32 v231, v90, v91
    v_cvt_pk_f16_f32 v151, v206, -v207
    v_cvt_pk_f16_f32 v153, v210, -v211
    v_cvt_pk_f16_f32 v135, v174, -v175
    ds_write2st64_b32 v102, v228, v229 offset0:12 offset1:13
    ds_write2st64_b32 v103, v230, v231 offset0:14 offset1:15
    ds_read_b128 v[216:219], v112
    ds_read_b128 v[220:223], v116
    ds_read_b128 v[224:227], v117
    ds_read_b128 v[228:231], v118
    v_pk_fma_f32 v[76:77], v[78:79], v[70:71], v[76:77] op_sel:[1,1,0] op_sel_hi:[0,1,1] neg_lo:[1,0,0]
    v_pk_fma_f32 v[80:81], v[82:83], v[70:71], v[80:81] op_sel:[1,1,0] op_sel_hi:[0,1,1] neg_lo:[1,0,0]
    v_pk_fma_f32 v[84:85], v[86:87], v[70:71], v[84:85] op_sel:[1,1,0] op_sel_hi:[0,1,1] neg_lo:[1,0,0]
    v_pk_fma_f32 v[88:89], v[90:91], v[70:71], v[88:89] op_sel:[1,1,0] op_sel_hi:[0,1,1] neg_lo:[1,0,0]
    v_pk_fma_f32 v[178:179], v[176:177], v[62:63], v[178:179] op_sel:[1,1,0] op_sel_hi:[0,1,1] neg_lo:[1,0,0]
    v_pk_fma_f32 v[180:181], v[176:177], v[64:65], v[180:181] op_sel:[1,1,0] op_sel_hi:[0,1,1] neg_lo:[1,0,0]
    v_pk_fma_f32 v[184:185], v[176:177], v[58:59], v[184:185] op_sel:[1,1,0] op_sel_hi:[0,1,1] neg_lo:[1,0,0]
    v_pk_mul_f32 v[78:79], v[76:77], v[70:71] op_sel_hi:[1,0]
    v_pk_mul_f32 v[82:83], v[80:81], v[70:71] op_sel_hi:[1,0]
    v_pk_mul_f32 v[86:87], v[84:85], v[70:71] op_sel_hi:[1,0]
    v_pk_mul_f32 v[90:91], v[88:89], v[70:71] op_sel_hi:[1,0]
    v_pk_mul_f32 v[182:183], v[178:179], v[64:65] op_sel_hi:[1,0]
    v_pk_mul_f32 v[188:189], v[186:187], v[64:65] op_sel_hi:[1,0]
    v_pk_mul_f32 v[190:191], v[186:187], v[58:59] op_sel_hi:[1,0]
    v_cvt_pk_f16_f32 v232, v76, v77
    v_cvt_pk_f16_f32 v233, v80, v81
    v_cvt_pk_f16_f32 v234, v84, v85
    v_cvt_pk_f16_f32 v235, v88, v89
    v_cvt_pk_f16_f32 v137, v178, -v179
    v_cvt_pk_f16_f32 v138, v180, -v181
    v_cvt_pk_f16_f32 v140, v184, -v185
    ds_write2st64_b32 v96, v232, v233 offset0:0 offset1:1
    ds_write2st64_b32 v97, v234, v235 offset0:2 offset1:3
    v_pk_fma_f32 v[78:79], v[76:77], v[70:71], v[78:79] op_sel:[1,1,0] op_sel_hi:[0,1,1] neg_lo:[1,0,0]
    v_pk_fma_f32 v[82:83], v[80:81], v[70:71], v[82:83] op_sel:[1,1,0] op_sel_hi:[0,1,1] neg_lo:[1,0,0]
    v_pk_fma_f32 v[86:87], v[84:85], v[70:71], v[86:87] op_sel:[1,1,0] op_sel_hi:[0,1,1] neg_lo:[1,0,0]
    v_pk_fma_f32 v[90:91], v[88:89], v[70:71], v[90:91] op_sel:[1,1,0] op_sel_hi:[0,1,1] neg_lo:[1,0,0]
    v_pk_fma_f32 v[182:183], v[178:179], v[64:65], v[182:183] op_sel:[1,1,0] op_sel_hi:[0,1,1] neg_lo:[1,0,0]
    v_pk_fma_f32 v[188:189], v[186:187], v[64:65], v[188:189] op_sel:[1,1,0] op_sel_hi:[0,1,1] neg_lo:[1,0,0]
    v_pk_fma_f32 v[190:191], v[186:187], v[58:59], v[190:191] op_sel:[1,1,0] op_sel_hi:[0,1,1] neg_lo:[1,0,0]
    v_pk_mul_f32 v[76:77], v[78:79], v[70:71] op_sel_hi:[1,0]
    v_pk_mul_f32 v[80:81], v[82:83], v[70:71] op_sel_hi:[1,0]
    v_pk_mul_f32 v[84:85], v[86:87], v[70:71] op_sel_hi:[1,0]
    v_pk_mul_f32 v[88:89], v[90:91], v[70:71] op_sel_hi:[1,0]
    v_pk_mul_f32 v[194:195], v[192:193], v[64:65] op_sel_hi:[1,0]
    v_pk_mul_f32 v[196:197], v[192:193], v[58:59] op_sel_hi:[1,0]
    v_pk_mul_f32 v[200:201], v[198:199], v[58:59] op_sel_hi:[1,0]
    v_cvt_pk_f16_f32 v236, v78, v79
    v_cvt_pk_f16_f32 v237, v82, v83
    v_cvt_pk_f16_f32 v238, v86, v87
    v_cvt_pk_f16_f32 v239, v90, v91
    v_cvt_pk_f16_f32 v139, v182, -v183
    v_cvt_pk_f16_f32 v142, v188, -v189
    v_cvt_pk_f16_f32 v143, v190, -v191
    ds_write2st64_b32 v98, v236, v237 offset0:4 offset1:5
    ds_write2st64_b32 v99, v238, v239 offset0:6 offset1:7
    v_pk_fma_f32 v[76:77], v[78:79], v[70:71], v[76:77] op_sel:[1,1,0] op_sel_hi:[0,1,1] neg_lo:[1,0,0]
    v_pk_fma_f32 v[80:81], v[82:83], v[70:71], v[80:81] op_sel:[1,1,0] op_sel_hi:[0,1,1] neg_lo:[1,0,0]
    v_pk_fma_f32 v[84:85], v[86:87], v[70:71], v[84:85] op_sel:[1,1,0] op_sel_hi:[0,1,1] neg_lo:[1,0,0]
    v_pk_fma_f32 v[88:89], v[90:91], v[70:71], v[88:89] op_sel:[1,1,0] op_sel_hi:[0,1,1] neg_lo:[1,0,0]
    v_pk_fma_f32 v[194:195], v[192:193], v[64:65], v[194:195] op_sel:[1,1,0] op_sel_hi:[0,1,1] neg_lo:[1,0,0]
    v_pk_fma_f32 v[196:197], v[192:193], v[58:59], v[196:197] op_sel:[1,1,0] op_sel_hi:[0,1,1] neg_lo:[1,0,0]
    v_pk_fma_f32 v[200:201], v[198:199], v[58:59], v[200:201] op_sel:[1,1,0] op_sel_hi:[0,1,1] neg_lo:[1,0,0]
    v_pk_mul_f32 v[78:79], v[76:77], v[70:71] op_sel_hi:[1,0]
    v_pk_mul_f32 v[82:83], v[80:81], v[70:71] op_sel_hi:[1,0]
    v_pk_mul_f32 v[86:87], v[84:85], v[70:71] op_sel_hi:[1,0]
    v_pk_mul_f32 v[90:91], v[88:89], v[70:71] op_sel_hi:[1,0]
    v_pk_mul_f32 v[204:205], v[202:203], v[58:59] op_sel_hi:[1,0]
    v_pk_mul_f32 v[208:209], v[206:207], v[58:59] op_sel_hi:[1,0]
    v_pk_mul_f32 v[212:213], v[210:211], v[58:59] op_sel_hi:[1,0]
    v_cvt_pk_f16_f32 v240, v76, v77
    v_cvt_pk_f16_f32 v241, v80, v81
    v_cvt_pk_f16_f32 v242, v84, v85
    v_cvt_pk_f16_f32 v243, v88, v89
    v_cvt_pk_f16_f32 v145, v194, -v195
    v_cvt_pk_f16_f32 v146, v196, -v197
    v_cvt_pk_f16_f32 v148, v200, -v201
    ds_write2st64_b32 v100, v240, v241 offset0:8 offset1:9
    ds_write2st64_b32 v101, v242, v243 offset0:10 offset1:11
    v_pk_fma_f32 v[78:79], v[76:77], v[70:71], v[78:79] op_sel:[1,1,0] op_sel_hi:[0,1,1] neg_lo:[1,0,0]
    v_pk_fma_f32 v[82:83], v[80:81], v[70:71], v[82:83] op_sel:[1,1,0] op_sel_hi:[0,1,1] neg_lo:[1,0,0]
    v_pk_fma_f32 v[86:87], v[84:85], v[70:71], v[86:87] op_sel:[1,1,0] op_sel_hi:[0,1,1] neg_lo:[1,0,0]
    v_pk_fma_f32 v[90:91], v[88:89], v[70:71], v[90:91] op_sel:[1,1,0] op_sel_hi:[0,1,1] neg_lo:[1,0,0]
    v_pk_fma_f32 v[204:205], v[202:203], v[58:59], v[204:205] op_sel:[1,1,0] op_sel_hi:[0,1,1] neg_lo:[1,0,0]
    v_pk_fma_f32 v[208:209], v[206:207], v[58:59], v[208:209] op_sel:[1,1,0] op_sel_hi:[0,1,1] neg_lo:[1,0,0]
    v_pk_fma_f32 v[212:213], v[210:211], v[58:59], v[212:213] op_sel:[1,1,0] op_sel_hi:[0,1,1] neg_lo:[1,0,0]
    v_cvt_pk_f16_f32 v244, v78, v79
    v_cvt_pk_f16_f32 v245, v82, v83
    v_cvt_pk_f16_f32 v246, v86, v87
    v_cvt_pk_f16_f32 v247, v90, v91
    v_cvt_pk_f16_f32 v150, v204, -v205
    v_cvt_pk_f16_f32 v152, v208, -v209
    v_cvt_pk_f16_f32 v154, v212, -v213
    ds_write2st64_b32 v102, v244, v245 offset0:12 offset1:13
    ds_write2st64_b32 v103, v246, v247 offset0:14 offset1:15
    ds_read_b128 v[232:235], v112
    ds_read_b128 v[236:239], v116
    ds_read_b128 v[240:243], v117
    ds_read_b128 v[244:247], v118
    ds_write2st64_b32 v96, v128, v129 offset0:0 offset1:1
    ds_write2st64_b32 v97, v130, v131 offset0:2 offset1:3
    ds_write2st64_b32 v98, v132, v133 offset0:4 offset1:5
    ds_write2st64_b32 v99, v134, v135 offset0:6 offset1:7
    ds_write2st64_b32 v100, v136, v137 offset0:8 offset1:9
    ds_write2st64_b32 v101, v138, v139 offset0:10 offset1:11
    ds_write_b32 v102, v140 offset:3072
    ds_read_b128 v[160:163], v113
    ds_read_b128 v[164:167], v119
    ds_read_b128 v[168:171], v120
    ds_read_b128 v[172:175], v121
    ds_write2st64_b32 v96, v141, v142 offset0:0 offset1:1
    ds_write2st64_b32 v97, v143, v144 offset0:2 offset1:3
    ds_write2st64_b32 v98, v145, v146 offset0:4 offset1:5
    ds_write2st64_b32 v99, v147, v148 offset0:6 offset1:7
    ds_write2st64_b32 v100, v149, v150 offset0:8 offset1:9
    ds_write2st64_b32 v101, v151, v152 offset0:10 offset1:11
    ds_write2st64_b32 v102, v153, v154 offset0:12 offset1:13
    ds_read_b128 v[176:179], v114
    ds_read_b128 v[180:183], v122
    ds_read_b128 v[184:187], v123
    ds_read_b128 v[188:191], v124
    ds_read_b128 v[192:195], v115
    ds_read_b128 v[196:199], v125
    ds_read_b128 v[200:203], v126
    ds_read_b128 v[204:207], v127
    v_mov_b32 v31, v46
    s_waitcnt lgkmcnt(15)
    v_mfma_f32_16x16x32_f16 v[64:67], v[160:163], v[216:219], 0
    v_mfma_f32_16x16x32_f16 v[68:71], v[160:163], v[232:235], 0
    v_mfma_f32_16x16x32_f16 v[64:67], v[164:167], v[220:223], v[64:67]
    v_mfma_f32_16x16x32_f16 v[68:71], v[164:167], v[236:239], v[68:71]
    v_mfma_f32_16x16x32_f16 v[64:67], v[168:171], v[224:227], v[64:67]
    v_mfma_f32_16x16x32_f16 v[68:71], v[168:171], v[240:243], v[68:71]
    v_mfma_f32_16x16x32_f16 v[64:67], v[172:175], v[228:231], v[64:67]
    v_mfma_f32_16x16x32_f16 v[68:71], v[172:175], v[244:247], v[68:71]
    s_waitcnt lgkmcnt(4)
    v_mfma_f32_16x16x32_f16 v[72:75], v[176:179], v[216:219], 0
    v_mfma_f32_16x16x32_f16 v[76:79], v[176:179], v[232:235], 0
    v_mfma_f32_16x16x32_f16 v[72:75], v[180:183], v[220:223], v[72:75]
    v_mfma_f32_16x16x32_f16 v[76:79], v[180:183], v[236:239], v[76:79]
    v_mfma_f32_16x16x32_f16 v[72:75], v[184:187], v[224:227], v[72:75]
    v_mfma_f32_16x16x32_f16 v[76:79], v[184:187], v[240:243], v[76:79]
    v_mfma_f32_16x16x32_f16 v[72:75], v[188:191], v[228:231], v[72:75]
    v_mfma_f32_16x16x32_f16 v[76:79], v[188:191], v[244:247], v[76:79]
    s_waitcnt lgkmcnt(0)
    v_mfma_f32_16x16x32_f16 v[80:83], v[192:195], v[216:219], 0
    v_mfma_f32_16x16x32_f16 v[84:87], v[192:195], v[232:235], 0
    v_mfma_f32_16x16x32_f16 v[80:83], v[196:199], v[220:223], v[80:83]
    v_mfma_f32_16x16x32_f16 v[84:87], v[196:199], v[236:239], v[84:87]
    v_mfma_f32_16x16x32_f16 v[80:83], v[200:203], v[224:227], v[80:83]
    v_mfma_f32_16x16x32_f16 v[84:87], v[200:203], v[240:243], v[84:87]
    v_mfma_f32_16x16x32_f16 v[80:83], v[204:207], v[228:231], v[80:83]
    v_mfma_f32_16x16x32_f16 v[84:87], v[204:207], v[244:247], v[84:87]
    v_mul_u32_u24 v8, 3072, v2
    v_lshl_add_u32 v8, v1, 4, v8
    v_add_u32 v8, 98304, v8
    v_xor_b32 v9, 1, v2
    v_mul_u32_u24 v9, 3072, v9
    v_lshl_add_u32 v9, v1, 4, v9
    v_add_u32 v9, 98304, v9
    v_lshlrev_b32 v10, 2, v2
    v_add_u32 v10, 163600, v10
    v_xor_b32 v11, 4, v10
    v_mov_b32 v12, 1
    s_and_b32 s30, s29, 1
    s_cmp_eq_u32 s30, 1
    s_nop 7
    s_cbranch_scc1 A_KX1
    ds_write_b128 v8, v[68:71] offset:0
    ds_write_b128 v8, v[76:79] offset:1024
    ds_write_b128 v8, v[84:87] offset:2048
    s_branch A_KXD
A_KX1:
    ds_write_b128 v8, v[64:67] offset:0
    ds_write_b128 v8, v[72:75] offset:1024
    ds_write_b128 v8, v[80:83] offset:2048
    v_mov_b32 v64, v68
    v_mov_b32 v65, v69
    v_mov_b32 v66, v70
    v_mov_b32 v67, v71
    v_mov_b32 v72, v76
    v_mov_b32 v73, v77
    v_mov_b32 v74, v78
    v_mov_b32 v75, v79
    v_mov_b32 v80, v84
    v_mov_b32 v81, v85
A_KXD:
    ds_write_b32 v10, v12
    v_and_b32 v48, 15, v1
    v_lshrrev_b32 v49, 4, v1
    v_and_b32 v52, 1, v2
    v_lshl_add_u32 v52, v52, 4, v48
    v_and_b32 v53, 1, v49
    v_lshlrev_b32 v53, 2, v53
    v_lshl_add_u32 v53, v52, 3, v53
    v_lshrrev_b32 v56, 1, v49
    v_lshl_add_u32 v53, v56, 8, v53
    v_lshlrev_b32 v53, 1, v53
    v_mul_u32_u24 v55, 61184, v28
    v_add_u32 v55, 86272, v55
    v_sub_u32 v53, v55, v53
    v_add_u32 v53, 3056, v53
    v_lshlrev_b32 v56, 3, v52
    v_lshl_add_u32 v56, v49, 8, v56
    v_lshlrev_b32 v56, 1, v56
    v_sub_u32 v56, v55, v56
    v_add_u32 v56, 2032, v56
    s_mov_b32 s39, 16000000
A_KXP_L:
    ds_read_b32 v7, v11 offset:0
    s_waitcnt lgkmcnt(0)
    v_cmp_gt_u32 vcc, 1, v7
    s_cbranch_vccz A_KXP_D
    s_sub_u32 s39, s39, 1
    s_cbranch_scc1 A_KXP_D
    s_sleep 1
    s_branch A_KXP_L
A_KXP_D:
    ds_read_b128 v[68:71], v9 offset:0
    ds_read_b128 v[76:79], v9 offset:1024
    ds_read_b128 v[84:87], v9 offset:2048
    s_waitcnt lgkmcnt(0)
    v_add_f32 v64, v64, v68
    v_mul_f32 v64, v31, v64
    v_add_f32 v65, v65, v69
    v_mul_f32 v65, v31, v65
    v_add_f32 v66, v66, v70
    v_mul_f32 v66, v31, v66
    v_add_f32 v67, v67, v71
    v_mul_f32 v67, v31, v67
    v_add_f32 v72, v72, v76
    v_mul_f32 v72, v31, v72
    v_add_f32 v73, v73, v77
    v_mul_f32 v73, v31, v73
    v_add_f32 v74, v74, v78
    v_mul_f32 v74, v31, v74
    v_add_f32 v75, v75, v79
    v_mul_f32 v75, v31, v75
    v_add_f32 v80, v80, v84
    v_mul_f32 v80, v31, v80
    v_add_f32 v81, v81, v85
    v_mul_f32 v81, v31, v81
    v_cvt_pk_bf16_f32 v112, v67, v66
    v_cvt_pk_bf16_f32 v113, v65, v64
    v_cvt_pk_bf16_f32 v114, v75, v74
    v_cvt_pk_bf16_f32 v115, v73, v72
    v_and_b32 v57, 1, v52
    v_cmp_eq_u32 vcc, 1, v57
    s_nop 1
    v_cndmask_b32 v57, v80, v81, vcc
    v_cvt_pk_bf16_f32 v116, v81, v81
    v_cvt_pk_bf16_f32 v117, v81, v57
    v_cvt_pk_bf16_f32 v118, v80, v80
    v_mov_b32 v119, v118
    v_mov_b32 v120, v53
    v_mov_b32 v121, v56
    s_waitcnt vmcnt(0) lgkmcnt(0)
    s_cmp_eq_u32 s28, 1
    s_cbranch_scc1 A_G1
    s_barrier
    s_barrier
    s_barrier
    s_mov_b32 s16, s60
    s_mov_b32 s17, s61
    s_mov_b32 s18, 0x1c0000
    s_mov_b32 s19, 0x00020000
    v_lshlrev_b32 v3, 10, v1
    s_lshr_b32 s31, s2, 3
    s_sub_u32 s31, s31, 28
    s_mul_i32 s31, s31, 458752
    s_add_u32 s32, s31, 393216
    s_lshl_b32 s30, s29, 17
    s_add_u32 s31, s31, s30
    s_add_u32 s33, s31, 65536
    s_cmp_eq_u32 s29, 3
    s_cselect_b32 s34, 512, 0
    s_cselect_b32 s33, s32, s33
    s_sub_u32 s33, s33, s34
    buffer_load_dword v15, v3, s[16:19], s33 offen offset:896
    buffer_load_dword v15, v3, s[16:19], s31 offen offset:896
    s_barrier
    s_barrier
    s_barrier
    s_barrier
    s_barrier
    s_barrier
    s_waitcnt vmcnt(0)
    ds_read_b64 v[16:17], v19 offset:32
    ds_write_b64 v120, v[112:113] offset:1032
    ds_write_b64 v120, v[112:113] offset:5248
    ds_write_b64 v120, v[114:115] offset:8
    ds_write_b64 v120, v[114:115] offset:4224
    ds_write_b128 v121, v[116:119]
    ds_write_b64 v121, v[116:117] offset:4216
    ds_write_b64 v121, v[118:119] offset:4224
    v_mov_b32 v6, 163584
    v_mov_b32 v12, 1
    s_mov_b64 exec, 1
    ds_add_u32 v6, v12
    s_mov_b64 exec, -1
    s_branch A_CONV
A_G1:
    s_mov_b32 s37, 0
    s_mov_b32 s36, 0
    s_mov_b32 s38, 49152
    s_barrier
    ds_read_b128 v[48:51], v24 offset:0
    ds_read_b128 v[52:55], v24 offset:4096
    ds_read_b64_tr_b16 v[32:33], v20 offset:0
    ds_read_b64_tr_b16 v[34:35], v20 offset:512
    ds_read_b64_tr_b16 v[36:37], v21 offset:0
    ds_read_b64_tr_b16 v[38:39], v21 offset:512
    ds_read_b64_tr_b16 v[40:41], v22 offset:0
    ds_read_b64_tr_b16 v[42:43], v22 offset:512
    ds_read_b64_tr_b16 v[44:45], v23 offset:0
    ds_read_b64_tr_b16 v[46:47], v23 offset:512
    s_waitcnt lgkmcnt(0)
    v_mfma_f32_32x32x16_bf16 v[128:143], v[32:35], v[48:51], 0
    ds_read_b128 v[72:75], v25 offset:0
    ds_read_b128 v[76:79], v25 offset:4096
    v_mfma_f32_32x32x16_bf16 v[144:159], v[32:35], v[52:55], 0
    ds_read_b64_tr_b16 v[56:57], v20 offset:2048
    ds_read_b64_tr_b16 v[58:59], v20 offset:2560
    v_mfma_f32_32x32x16_bf16 v[160:175], v[36:39], v[48:51], 0
    ds_read_b64_tr_b16 v[60:61], v21 offset:2048
    ds_read_b64_tr_b16 v[62:63], v21 offset:2560
    v_mfma_f32_32x32x16_bf16 v[176:191], v[36:39], v[52:55], 0
    ds_read_b64_tr_b16 v[64:65], v22 offset:2048
    ds_read_b64_tr_b16 v[66:67], v22 offset:2560
    v_mfma_f32_32x32x16_bf16 v[192:207], v[40:43], v[48:51], 0
    ds_read_b64_tr_b16 v[68:69], v23 offset:2048
    ds_read_b64_tr_b16 v[70:71], v23 offset:2560
    v_mfma_f32_32x32x16_bf16 v[208:223], v[40:43], v[52:55], 0
    v_mfma_f32_32x32x16_bf16 v[224:239], v[44:47], v[48:51], 0
    v_mfma_f32_32x32x16_bf16 v[240:255], v[44:47], v[52:55], 0
    s_branch A_K1
A_LOOP:
    s_waitcnt lgkmcnt(0)
    v_mfma_f32_32x32x16_bf16 v[128:143], v[32:35], v[48:51], v[128:143]
    ds_read_b128 v[72:75], v25 offset:0
    ds_read_b128 v[76:79], v25 offset:4096
    v_mfma_f32_32x32x16_bf16 v[144:159], v[32:35], v[52:55], v[144:159]
    ds_read_b64_tr_b16 v[56:57], v20 offset:2048
    ds_read_b64_tr_b16 v[58:59], v20 offset:2560
    v_mfma_f32_32x32x16_bf16 v[160:175], v[36:39], v[48:51], v[160:175]
    ds_read_b64_tr_b16 v[60:61], v21 offset:2048
    ds_read_b64_tr_b16 v[62:63], v21 offset:2560
    v_mfma_f32_32x32x16_bf16 v[176:191], v[36:39], v[52:55], v[176:191]
    ds_read_b64_tr_b16 v[64:65], v22 offset:2048
    ds_read_b64_tr_b16 v[66:67], v22 offset:2560
    v_mfma_f32_32x32x16_bf16 v[192:207], v[40:43], v[48:51], v[192:207]
    ds_read_b64_tr_b16 v[68:69], v23 offset:2048
    ds_read_b64_tr_b16 v[70:71], v23 offset:2560
    v_mfma_f32_32x32x16_bf16 v[208:223], v[40:43], v[52:55], v[208:223]
    v_mfma_f32_32x32x16_bf16 v[224:239], v[44:47], v[48:51], v[224:239]
    v_mfma_f32_32x32x16_bf16 v[240:255], v[44:47], v[52:55], v[240:255]
A_K1:
    s_waitcnt lgkmcnt(0)
    v_mfma_f32_32x32x16_bf16 v[128:143], v[56:59], v[72:75], v[128:143]
    ds_read_b128 v[48:51], v26 offset:0
    ds_read_b128 v[52:55], v26 offset:4096
    v_mfma_f32_32x32x16_bf16 v[144:159], v[56:59], v[76:79], v[144:159]
    ds_read_b64_tr_b16 v[32:33], v20 offset:4096
    ds_read_b64_tr_b16 v[34:35], v20 offset:4608
    v_mfma_f32_32x32x16_bf16 v[160:175], v[60:63], v[72:75], v[160:175]
    ds_read_b64_tr_b16 v[36:37], v21 offset:4096
    ds_read_b64_tr_b16 v[38:39], v21 offset:4608
    v_mfma_f32_32x32x16_bf16 v[176:191], v[60:63], v[76:79], v[176:191]
    ds_read_b64_tr_b16 v[40:41], v22 offset:4096
    ds_read_b64_tr_b16 v[42:43], v22 offset:4608
    v_mfma_f32_32x32x16_bf16 v[192:207], v[64:67], v[72:75], v[192:207]
    ds_read_b64_tr_b16 v[44:45], v23 offset:4096
    ds_read_b64_tr_b16 v[46:47], v23 offset:4608
    v_mfma_f32_32x32x16_bf16 v[208:223], v[64:67], v[76:79], v[208:223]
    v_mfma_f32_32x32x16_bf16 v[224:239], v[68:71], v[72:75], v[224:239]
    v_mfma_f32_32x32x16_bf16 v[240:255], v[68:71], v[76:79], v[240:255]
    s_waitcnt lgkmcnt(0)
    v_mfma_f32_32x32x16_bf16 v[128:143], v[32:35], v[48:51], v[128:143]
    ds_read_b128 v[72:75], v27 offset:0
    ds_read_b128 v[76:79], v27 offset:4096
    v_mfma_f32_32x32x16_bf16 v[144:159], v[32:35], v[52:55], v[144:159]
    ds_read_b64_tr_b16 v[56:57], v20 offset:6144
    ds_read_b64_tr_b16 v[58:59], v20 offset:6656
    v_mfma_f32_32x32x16_bf16 v[160:175], v[36:39], v[48:51], v[160:175]
    ds_read_b64_tr_b16 v[60:61], v21 offset:6144
    ds_read_b64_tr_b16 v[62:63], v21 offset:6656
    v_mfma_f32_32x32x16_bf16 v[176:191], v[36:39], v[52:55], v[176:191]
    ds_read_b64_tr_b16 v[64:65], v22 offset:6144
    ds_read_b64_tr_b16 v[66:67], v22 offset:6656
    v_mfma_f32_32x32x16_bf16 v[192:207], v[40:43], v[48:51], v[192:207]
    ds_read_b64_tr_b16 v[68:69], v23 offset:6144
    ds_read_b64_tr_b16 v[70:71], v23 offset:6656
    v_mfma_f32_32x32x16_bf16 v[208:223], v[40:43], v[52:55], v[208:223]
    s_cmp_eq_u32 s36, 98304
    s_cselect_b32 s39, 4294868992, s38
    v_add_u32 v20, s39, v20
    v_add_u32 v21, s39, v21
    v_mfma_f32_32x32x16_bf16 v[224:239], v[44:47], v[48:51], v[224:239]
    v_add_u32 v22, s39, v22
    v_add_u32 v23, s39, v23
    v_add_u32 v24, s39, v24
    v_add_u32 v25, s39, v25
    v_mfma_f32_32x32x16_bf16 v[240:255], v[44:47], v[52:55], v[240:255]
    v_add_u32 v26, s39, v26
    v_add_u32 v27, s39, v27
    s_waitcnt lgkmcnt(0)
    s_barrier
    v_mfma_f32_32x32x16_bf16 v[128:143], v[56:59], v[72:75], v[128:143]
    ds_read_b128 v[48:51], v24 offset:0
    ds_read_b128 v[52:55], v24 offset:4096
    v_mfma_f32_32x32x16_bf16 v[144:159], v[56:59], v[76:79], v[144:159]
    ds_read_b64_tr_b16 v[32:33], v20 offset:0
    ds_read_b64_tr_b16 v[34:35], v20 offset:512
    v_mfma_f32_32x32x16_bf16 v[160:175], v[60:63], v[72:75], v[160:175]
    ds_read_b64_tr_b16 v[36:37], v21 offset:0
    ds_read_b64_tr_b16 v[38:39], v21 offset:512
    v_mfma_f32_32x32x16_bf16 v[176:191], v[60:63], v[76:79], v[176:191]
    ds_read_b64_tr_b16 v[40:41], v22 offset:0
    ds_read_b64_tr_b16 v[42:43], v22 offset:512
    v_mfma_f32_32x32x16_bf16 v[192:207], v[64:67], v[72:75], v[192:207]
    ds_read_b64_tr_b16 v[44:45], v23 offset:0
    ds_read_b64_tr_b16 v[46:47], v23 offset:512
    v_mfma_f32_32x32x16_bf16 v[208:223], v[64:67], v[76:79], v[208:223]
    s_add_u32 s36, s36, s39
    s_add_u32 s37, s37, 1
    s_cmp_lt_u32 s37, 8
    v_mfma_f32_32x32x16_bf16 v[224:239], v[68:71], v[72:75], v[224:239]
    v_mfma_f32_32x32x16_bf16 v[240:255], v[68:71], v[76:79], v[240:255]
    s_cbranch_scc1 A_LOOP
    s_setprio 3
    v_lshrrev_b32 v12, 5, v1
    v_lshlrev_b32 v12, 4, v12
    v_add_u32 v12, 163072, v12
    s_waitcnt lgkmcnt(0)
    ds_read_b64 v[4:5], v18
    ds_read_b64 v[6:7], v18 offset:256
    ds_read_b64 v[16:17], v19 offset:32
    ds_read_b128 v[32:35], v12 offset:0
    ds_read_b128 v[40:43], v12 offset:256
    ds_read_b128 v[36:39], v12 offset:32
    ds_read_b128 v[44:47], v12 offset:288
    ds_read_b128 v[48:51], v12 offset:64
    ds_read_b128 v[56:59], v12 offset:320
    ds_read_b128 v[52:55], v12 offset:96
    ds_read_b128 v[60:63], v12 offset:352
    ds_read_b128 v[64:67], v12 offset:128
    ds_read_b128 v[72:75], v12 offset:384
    ds_read_b128 v[68:71], v12 offset:160
    ds_read_b128 v[76:79], v12 offset:416
    ds_read_b128 v[80:83], v12 offset:192
    ds_read_b128 v[88:91], v12 offset:448
    ds_read_b128 v[84:87], v12 offset:224
    ds_read_b128 v[92:95], v12 offset:480
    s_lshl_b32 s31, s24, 3
    s_lshl_b32 s30, s29, 1
    s_add_u32 s31, s31, s30
    s_mul_i32 s31, s31, 112
    s_lshl_b32 s30, s25, 2
    s_add_u32 s31, s31, s30
    s_lshl_b32 s31, s31, 10
    s_add_u32 s31, s31, 4194304
    s_add_u32 s30, s31, 114688
    s_lshl_b32 s35, s24, 2
    s_add_u32 s35, s35, s29
    s_mul_i32 s35, s35, 28
    s_add_u32 s35, s35, s25
    s_lshl_b32 s35, s35, 7
    s_add_u32 s35, s35, 327680
    v_lshlrev_b32 v3, 4, v1
    v_mov_b32 v15, 0
    s_waitcnt lgkmcnt(0)
    v_sub_f32 v8, 0, v4
    v_mul_f32 v9, 0xbfb8aa3b, v5
    v_mul_f32 v10, v5, v5
    v_rcp_f32 v10, v10
    v_sub_f32 v12, 0, v6
    v_mul_f32 v13, 0xbfb8aa3b, v7
    v_mul_f32 v14, v7, v7
    v_rcp_f32 v14, v14
    v_pk_fma_f32 v[128:129], v[32:33], v[8:9], v[128:129] op_sel_hi:[1,0,1]
    v_pk_fma_f32 v[136:137], v[40:41], v[8:9], v[136:137] op_sel_hi:[1,0,1]
    v_pk_mul_f32 v[96:97], v[8:9], v[128:129] op_sel:[1,0] op_sel_hi:[1,1]
    v_pk_fma_f32 v[130:131], v[34:35], v[8:9], v[130:131] op_sel_hi:[1,0,1]
    v_pk_fma_f32 v[138:139], v[42:43], v[8:9], v[138:139] op_sel_hi:[1,0,1]
    v_pk_mul_f32 v[98:99], v[8:9], v[130:131] op_sel:[1,0] op_sel_hi:[1,1]
    v_pk_fma_f32 v[132:133], v[36:37], v[8:9], v[132:133] op_sel_hi:[1,0,1]
    v_pk_fma_f32 v[140:141], v[44:45], v[8:9], v[140:141] op_sel_hi:[1,0,1]
    v_pk_mul_f32 v[100:101], v[8:9], v[132:133] op_sel:[1,0] op_sel_hi:[1,1]
    v_pk_fma_f32 v[134:135], v[38:39], v[8:9], v[134:135] op_sel_hi:[1,0,1]
    v_pk_fma_f32 v[142:143], v[46:47], v[8:9], v[142:143] op_sel_hi:[1,0,1]
    v_pk_mul_f32 v[102:103], v[8:9], v[134:135] op_sel:[1,0] op_sel_hi:[1,1]
    v_exp_f32 v96, v96
    v_exp_f32 v97, v97
    v_exp_f32 v98, v98
    v_exp_f32 v99, v99
    v_exp_f32 v100, v100
    v_exp_f32 v101, v101
    v_exp_f32 v102, v102
    v_exp_f32 v103, v103
    v_pk_mul_f32 v[128:129], v[128:129], v[136:137]
    v_pk_fma_f32 v[96:97], v[96:97], v[10:11], v[10:11] op_sel_hi:[1,0,0]
    v_pk_mul_f32 v[130:131], v[130:131], v[138:139]
    v_pk_fma_f32 v[98:99], v[98:99], v[10:11], v[10:11] op_sel_hi:[1,0,0]
    v_pk_mul_f32 v[132:133], v[132:133], v[140:141]
    v_pk_fma_f32 v[100:101], v[100:101], v[10:11], v[10:11] op_sel_hi:[1,0,0]
    v_pk_mul_f32 v[134:135], v[134:135], v[142:143]
    v_pk_fma_f32 v[102:103], v[102:103], v[10:11], v[10:11] op_sel_hi:[1,0,0]
    v_rcp_f32 v96, v96
    v_rcp_f32 v97, v97
    v_rcp_f32 v98, v98
    v_rcp_f32 v99, v99
    v_rcp_f32 v100, v100
    v_rcp_f32 v101, v101
    v_rcp_f32 v102, v102
    v_rcp_f32 v103, v103
    v_pk_mul_f32 v[128:129], v[128:129], v[96:97]
    v_pk_mul_f32 v[130:131], v[130:131], v[98:99]
    v_pk_mul_f32 v[132:133], v[132:133], v[100:101]
    v_pk_mul_f32 v[134:135], v[134:135], v[102:103]
    v_cvt_pk_bf16_f32 v136, v128, v129
    v_cvt_pk_bf16_f32 v137, v130, v131
    v_cvt_pk_bf16_f32 v138, v132, v133
    v_cvt_pk_bf16_f32 v139, v134, v135
    buffer_store_dwordx4 v[136:139], v3, s[8:11], s31 offen offset:0 sc1
    v_pk_fma_f32 v[144:145], v[32:33], v[12:13], v[144:145] op_sel_hi:[1,0,1]
    v_pk_fma_f32 v[152:153], v[40:41], v[12:13], v[152:153] op_sel_hi:[1,0,1]
    v_pk_mul_f32 v[96:97], v[12:13], v[144:145] op_sel:[1,0] op_sel_hi:[1,1]
    v_pk_fma_f32 v[146:147], v[34:35], v[12:13], v[146:147] op_sel_hi:[1,0,1]
    v_pk_fma_f32 v[154:155], v[42:43], v[12:13], v[154:155] op_sel_hi:[1,0,1]
    v_pk_mul_f32 v[98:99], v[12:13], v[146:147] op_sel:[1,0] op_sel_hi:[1,1]
    v_pk_fma_f32 v[148:149], v[36:37], v[12:13], v[148:149] op_sel_hi:[1,0,1]
    v_pk_fma_f32 v[156:157], v[44:45], v[12:13], v[156:157] op_sel_hi:[1,0,1]
    v_pk_mul_f32 v[100:101], v[12:13], v[148:149] op_sel:[1,0] op_sel_hi:[1,1]
    v_pk_fma_f32 v[150:151], v[38:39], v[12:13], v[150:151] op_sel_hi:[1,0,1]
    v_pk_fma_f32 v[158:159], v[46:47], v[12:13], v[158:159] op_sel_hi:[1,0,1]
    v_pk_mul_f32 v[102:103], v[12:13], v[150:151] op_sel:[1,0] op_sel_hi:[1,1]
    v_exp_f32 v96, v96
    v_exp_f32 v97, v97
    v_exp_f32 v98, v98
    v_exp_f32 v99, v99
    v_exp_f32 v100, v100
    v_exp_f32 v101, v101
    v_exp_f32 v102, v102
    v_exp_f32 v103, v103
    v_pk_mul_f32 v[144:145], v[144:145], v[152:153]
    v_pk_fma_f32 v[96:97], v[96:97], v[14:15], v[14:15] op_sel_hi:[1,0,0]
    v_pk_mul_f32 v[146:147], v[146:147], v[154:155]
    v_pk_fma_f32 v[98:99], v[98:99], v[14:15], v[14:15] op_sel_hi:[1,0,0]
    v_pk_mul_f32 v[148:149], v[148:149], v[156:157]
    v_pk_fma_f32 v[100:101], v[100:101], v[14:15], v[14:15] op_sel_hi:[1,0,0]
    v_pk_mul_f32 v[150:151], v[150:151], v[158:159]
    v_pk_fma_f32 v[102:103], v[102:103], v[14:15], v[14:15] op_sel_hi:[1,0,0]
    v_rcp_f32 v96, v96
    v_rcp_f32 v97, v97
    v_rcp_f32 v98, v98
    v_rcp_f32 v99, v99
    v_rcp_f32 v100, v100
    v_rcp_f32 v101, v101
    v_rcp_f32 v102, v102
    v_rcp_f32 v103, v103
    v_pk_mul_f32 v[144:145], v[144:145], v[96:97]
    v_pk_mul_f32 v[146:147], v[146:147], v[98:99]
    v_pk_mul_f32 v[148:149], v[148:149], v[100:101]
    v_pk_mul_f32 v[150:151], v[150:151], v[102:103]
    v_cvt_pk_bf16_f32 v152, v144, v145
    v_cvt_pk_bf16_f32 v153, v146, v147
    v_cvt_pk_bf16_f32 v154, v148, v149
    v_cvt_pk_bf16_f32 v155, v150, v151
    buffer_store_dwordx4 v[152:155], v3, s[8:11], s30 offen offset:0 sc1
    v_pk_fma_f32 v[160:161], v[48:49], v[8:9], v[160:161] op_sel_hi:[1,0,1]
    v_pk_fma_f32 v[168:169], v[56:57], v[8:9], v[168:169] op_sel_hi:[1,0,1]
    v_pk_mul_f32 v[96:97], v[8:9], v[160:161] op_sel:[1,0] op_sel_hi:[1,1]
    v_pk_fma_f32 v[162:163], v[50:51], v[8:9], v[162:163] op_sel_hi:[1,0,1]
    v_pk_fma_f32 v[170:171], v[58:59], v[8:9], v[170:171] op_sel_hi:[1,0,1]
    v_pk_mul_f32 v[98:99], v[8:9], v[162:163] op_sel:[1,0] op_sel_hi:[1,1]
    v_pk_fma_f32 v[164:165], v[52:53], v[8:9], v[164:165] op_sel_hi:[1,0,1]
    v_pk_fma_f32 v[172:173], v[60:61], v[8:9], v[172:173] op_sel_hi:[1,0,1]
    v_pk_mul_f32 v[100:101], v[8:9], v[164:165] op_sel:[1,0] op_sel_hi:[1,1]
    v_pk_fma_f32 v[166:167], v[54:55], v[8:9], v[166:167] op_sel_hi:[1,0,1]
    v_pk_fma_f32 v[174:175], v[62:63], v[8:9], v[174:175] op_sel_hi:[1,0,1]
    v_pk_mul_f32 v[102:103], v[8:9], v[166:167] op_sel:[1,0] op_sel_hi:[1,1]
    v_exp_f32 v96, v96
    v_exp_f32 v97, v97
    v_exp_f32 v98, v98
    v_exp_f32 v99, v99
    v_exp_f32 v100, v100
    v_exp_f32 v101, v101
    v_exp_f32 v102, v102
    v_exp_f32 v103, v103
    v_pk_mul_f32 v[160:161], v[160:161], v[168:169]
    v_pk_fma_f32 v[96:97], v[96:97], v[10:11], v[10:11] op_sel_hi:[1,0,0]
    v_pk_mul_f32 v[162:163], v[162:163], v[170:171]
    v_pk_fma_f32 v[98:99], v[98:99], v[10:11], v[10:11] op_sel_hi:[1,0,0]
    v_pk_mul_f32 v[164:165], v[164:165], v[172:173]
    v_pk_fma_f32 v[100:101], v[100:101], v[10:11], v[10:11] op_sel_hi:[1,0,0]
    v_pk_mul_f32 v[166:167], v[166:167], v[174:175]
    v_pk_fma_f32 v[102:103], v[102:103], v[10:11], v[10:11] op_sel_hi:[1,0,0]
    v_rcp_f32 v96, v96
    v_rcp_f32 v97, v97
    v_rcp_f32 v98, v98
    v_rcp_f32 v99, v99
    v_rcp_f32 v100, v100
    v_rcp_f32 v101, v101
    v_rcp_f32 v102, v102
    v_rcp_f32 v103, v103
    v_pk_mul_f32 v[160:161], v[160:161], v[96:97]
    v_pk_mul_f32 v[162:163], v[162:163], v[98:99]
    v_pk_mul_f32 v[164:165], v[164:165], v[100:101]
    v_pk_mul_f32 v[166:167], v[166:167], v[102:103]
    v_cvt_pk_bf16_f32 v168, v160, v161
    v_cvt_pk_bf16_f32 v169, v162, v163
    v_cvt_pk_bf16_f32 v170, v164, v165
    v_cvt_pk_bf16_f32 v171, v166, v167
    buffer_store_dwordx4 v[168:171], v3, s[8:11], s31 offen offset:1024 sc1
    v_pk_fma_f32 v[176:177], v[48:49], v[12:13], v[176:177] op_sel_hi:[1,0,1]
    v_pk_fma_f32 v[184:185], v[56:57], v[12:13], v[184:185] op_sel_hi:[1,0,1]
    v_pk_mul_f32 v[96:97], v[12:13], v[176:177] op_sel:[1,0] op_sel_hi:[1,1]
    v_pk_fma_f32 v[178:179], v[50:51], v[12:13], v[178:179] op_sel_hi:[1,0,1]
    v_pk_fma_f32 v[186:187], v[58:59], v[12:13], v[186:187] op_sel_hi:[1,0,1]
    v_pk_mul_f32 v[98:99], v[12:13], v[178:179] op_sel:[1,0] op_sel_hi:[1,1]
    v_pk_fma_f32 v[180:181], v[52:53], v[12:13], v[180:181] op_sel_hi:[1,0,1]
    v_pk_fma_f32 v[188:189], v[60:61], v[12:13], v[188:189] op_sel_hi:[1,0,1]
    v_pk_mul_f32 v[100:101], v[12:13], v[180:181] op_sel:[1,0] op_sel_hi:[1,1]
    v_pk_fma_f32 v[182:183], v[54:55], v[12:13], v[182:183] op_sel_hi:[1,0,1]
    v_pk_fma_f32 v[190:191], v[62:63], v[12:13], v[190:191] op_sel_hi:[1,0,1]
    v_pk_mul_f32 v[102:103], v[12:13], v[182:183] op_sel:[1,0] op_sel_hi:[1,1]
    v_exp_f32 v96, v96
    v_exp_f32 v97, v97
    v_exp_f32 v98, v98
    v_exp_f32 v99, v99
    v_exp_f32 v100, v100
    v_exp_f32 v101, v101
    v_exp_f32 v102, v102
    v_exp_f32 v103, v103
    v_pk_mul_f32 v[176:177], v[176:177], v[184:185]
    v_pk_fma_f32 v[96:97], v[96:97], v[14:15], v[14:15] op_sel_hi:[1,0,0]
    v_pk_mul_f32 v[178:179], v[178:179], v[186:187]
    v_pk_fma_f32 v[98:99], v[98:99], v[14:15], v[14:15] op_sel_hi:[1,0,0]
    v_pk_mul_f32 v[180:181], v[180:181], v[188:189]
    v_pk_fma_f32 v[100:101], v[100:101], v[14:15], v[14:15] op_sel_hi:[1,0,0]
    v_pk_mul_f32 v[182:183], v[182:183], v[190:191]
    v_pk_fma_f32 v[102:103], v[102:103], v[14:15], v[14:15] op_sel_hi:[1,0,0]
    v_rcp_f32 v96, v96
    v_rcp_f32 v97, v97
    v_rcp_f32 v98, v98
    v_rcp_f32 v99, v99
    v_rcp_f32 v100, v100
    v_rcp_f32 v101, v101
    v_rcp_f32 v102, v102
    v_rcp_f32 v103, v103
    v_pk_mul_f32 v[176:177], v[176:177], v[96:97]
    v_pk_mul_f32 v[178:179], v[178:179], v[98:99]
    v_pk_mul_f32 v[180:181], v[180:181], v[100:101]
    v_pk_mul_f32 v[182:183], v[182:183], v[102:103]
    v_cvt_pk_bf16_f32 v184, v176, v177
    v_cvt_pk_bf16_f32 v185, v178, v179
    v_cvt_pk_bf16_f32 v186, v180, v181
    v_cvt_pk_bf16_f32 v187, v182, v183
    buffer_store_dwordx4 v[184:187], v3, s[8:11], s30 offen offset:1024 sc1
    v_pk_fma_f32 v[192:193], v[64:65], v[8:9], v[192:193] op_sel_hi:[1,0,1]
    v_pk_fma_f32 v[200:201], v[72:73], v[8:9], v[200:201] op_sel_hi:[1,0,1]
    v_pk_mul_f32 v[96:97], v[8:9], v[192:193] op_sel:[1,0] op_sel_hi:[1,1]
    v_pk_fma_f32 v[194:195], v[66:67], v[8:9], v[194:195] op_sel_hi:[1,0,1]
    v_pk_fma_f32 v[202:203], v[74:75], v[8:9], v[202:203] op_sel_hi:[1,0,1]
    v_pk_mul_f32 v[98:99], v[8:9], v[194:195] op_sel:[1,0] op_sel_hi:[1,1]
    v_pk_fma_f32 v[196:197], v[68:69], v[8:9], v[196:197] op_sel_hi:[1,0,1]
    v_pk_fma_f32 v[204:205], v[76:77], v[8:9], v[204:205] op_sel_hi:[1,0,1]
    v_pk_mul_f32 v[100:101], v[8:9], v[196:197] op_sel:[1,0] op_sel_hi:[1,1]
    v_pk_fma_f32 v[198:199], v[70:71], v[8:9], v[198:199] op_sel_hi:[1,0,1]
    v_pk_fma_f32 v[206:207], v[78:79], v[8:9], v[206:207] op_sel_hi:[1,0,1]
    v_pk_mul_f32 v[102:103], v[8:9], v[198:199] op_sel:[1,0] op_sel_hi:[1,1]
    v_exp_f32 v96, v96
    v_exp_f32 v97, v97
    v_exp_f32 v98, v98
    v_exp_f32 v99, v99
    v_exp_f32 v100, v100
    v_exp_f32 v101, v101
    v_exp_f32 v102, v102
    v_exp_f32 v103, v103
    v_pk_mul_f32 v[192:193], v[192:193], v[200:201]
    v_pk_fma_f32 v[96:97], v[96:97], v[10:11], v[10:11] op_sel_hi:[1,0,0]
    v_pk_mul_f32 v[194:195], v[194:195], v[202:203]
    v_pk_fma_f32 v[98:99], v[98:99], v[10:11], v[10:11] op_sel_hi:[1,0,0]
    v_pk_mul_f32 v[196:197], v[196:197], v[204:205]
    v_pk_fma_f32 v[100:101], v[100:101], v[10:11], v[10:11] op_sel_hi:[1,0,0]
    v_pk_mul_f32 v[198:199], v[198:199], v[206:207]
    v_pk_fma_f32 v[102:103], v[102:103], v[10:11], v[10:11] op_sel_hi:[1,0,0]
    v_rcp_f32 v96, v96
    v_rcp_f32 v97, v97
    v_rcp_f32 v98, v98
    v_rcp_f32 v99, v99
    v_rcp_f32 v100, v100
    v_rcp_f32 v101, v101
    v_rcp_f32 v102, v102
    v_rcp_f32 v103, v103
    v_pk_mul_f32 v[192:193], v[192:193], v[96:97]
    v_pk_mul_f32 v[194:195], v[194:195], v[98:99]
    v_pk_mul_f32 v[196:197], v[196:197], v[100:101]
    v_pk_mul_f32 v[198:199], v[198:199], v[102:103]
    v_cvt_pk_bf16_f32 v200, v192, v193
    v_cvt_pk_bf16_f32 v201, v194, v195
    v_cvt_pk_bf16_f32 v202, v196, v197
    v_cvt_pk_bf16_f32 v203, v198, v199
    buffer_store_dwordx4 v[200:203], v3, s[8:11], s31 offen offset:2048 sc1
    v_pk_fma_f32 v[208:209], v[64:65], v[12:13], v[208:209] op_sel_hi:[1,0,1]
    v_pk_fma_f32 v[216:217], v[72:73], v[12:13], v[216:217] op_sel_hi:[1,0,1]
    v_pk_mul_f32 v[96:97], v[12:13], v[208:209] op_sel:[1,0] op_sel_hi:[1,1]
    v_pk_fma_f32 v[210:211], v[66:67], v[12:13], v[210:211] op_sel_hi:[1,0,1]
    v_pk_fma_f32 v[218:219], v[74:75], v[12:13], v[218:219] op_sel_hi:[1,0,1]
    v_pk_mul_f32 v[98:99], v[12:13], v[210:211] op_sel:[1,0] op_sel_hi:[1,1]
    v_pk_fma_f32 v[212:213], v[68:69], v[12:13], v[212:213] op_sel_hi:[1,0,1]
    v_pk_fma_f32 v[220:221], v[76:77], v[12:13], v[220:221] op_sel_hi:[1,0,1]
    v_pk_mul_f32 v[100:101], v[12:13], v[212:213] op_sel:[1,0] op_sel_hi:[1,1]
    v_pk_fma_f32 v[214:215], v[70:71], v[12:13], v[214:215] op_sel_hi:[1,0,1]
    v_pk_fma_f32 v[222:223], v[78:79], v[12:13], v[222:223] op_sel_hi:[1,0,1]
    v_pk_mul_f32 v[102:103], v[12:13], v[214:215] op_sel:[1,0] op_sel_hi:[1,1]
    v_exp_f32 v96, v96
    v_exp_f32 v97, v97
    v_exp_f32 v98, v98
    v_exp_f32 v99, v99
    v_exp_f32 v100, v100
    v_exp_f32 v101, v101
    v_exp_f32 v102, v102
    v_exp_f32 v103, v103
    v_pk_mul_f32 v[208:209], v[208:209], v[216:217]
    v_pk_fma_f32 v[96:97], v[96:97], v[14:15], v[14:15] op_sel_hi:[1,0,0]
    v_pk_mul_f32 v[210:211], v[210:211], v[218:219]
    v_pk_fma_f32 v[98:99], v[98:99], v[14:15], v[14:15] op_sel_hi:[1,0,0]
    v_pk_mul_f32 v[212:213], v[212:213], v[220:221]
    v_pk_fma_f32 v[100:101], v[100:101], v[14:15], v[14:15] op_sel_hi:[1,0,0]
    v_pk_mul_f32 v[214:215], v[214:215], v[222:223]
    v_pk_fma_f32 v[102:103], v[102:103], v[14:15], v[14:15] op_sel_hi:[1,0,0]
    v_rcp_f32 v96, v96
    v_rcp_f32 v97, v97
    v_rcp_f32 v98, v98
    v_rcp_f32 v99, v99
    v_rcp_f32 v100, v100
    v_rcp_f32 v101, v101
    v_rcp_f32 v102, v102
    v_rcp_f32 v103, v103
    v_pk_mul_f32 v[208:209], v[208:209], v[96:97]
    v_pk_mul_f32 v[210:211], v[210:211], v[98:99]
    v_pk_mul_f32 v[212:213], v[212:213], v[100:101]
    v_pk_mul_f32 v[214:215], v[214:215], v[102:103]
    v_cvt_pk_bf16_f32 v216, v208, v209
    v_cvt_pk_bf16_f32 v217, v210, v211
    v_cvt_pk_bf16_f32 v218, v212, v213
    v_cvt_pk_bf16_f32 v219, v214, v215
    buffer_store_dwordx4 v[216:219], v3, s[8:11], s30 offen offset:2048 sc1
    v_pk_fma_f32 v[224:225], v[80:81], v[8:9], v[224:225] op_sel_hi:[1,0,1]
    v_pk_fma_f32 v[232:233], v[88:89], v[8:9], v[232:233] op_sel_hi:[1,0,1]
    v_pk_mul_f32 v[96:97], v[8:9], v[224:225] op_sel:[1,0] op_sel_hi:[1,1]
    v_pk_fma_f32 v[226:227], v[82:83], v[8:9], v[226:227] op_sel_hi:[1,0,1]
    v_pk_fma_f32 v[234:235], v[90:91], v[8:9], v[234:235] op_sel_hi:[1,0,1]
    v_pk_mul_f32 v[98:99], v[8:9], v[226:227] op_sel:[1,0] op_sel_hi:[1,1]
    v_pk_fma_f32 v[228:229], v[84:85], v[8:9], v[228:229] op_sel_hi:[1,0,1]
    v_pk_fma_f32 v[236:237], v[92:93], v[8:9], v[236:237] op_sel_hi:[1,0,1]
    v_pk_mul_f32 v[100:101], v[8:9], v[228:229] op_sel:[1,0] op_sel_hi:[1,1]
    v_pk_fma_f32 v[230:231], v[86:87], v[8:9], v[230:231] op_sel_hi:[1,0,1]
    v_pk_fma_f32 v[238:239], v[94:95], v[8:9], v[238:239] op_sel_hi:[1,0,1]
    v_pk_mul_f32 v[102:103], v[8:9], v[230:231] op_sel:[1,0] op_sel_hi:[1,1]
    v_exp_f32 v96, v96
    v_exp_f32 v97, v97
    v_exp_f32 v98, v98
    v_exp_f32 v99, v99
    v_exp_f32 v100, v100
    v_exp_f32 v101, v101
    v_exp_f32 v102, v102
    v_exp_f32 v103, v103
    v_pk_mul_f32 v[224:225], v[224:225], v[232:233]
    v_pk_fma_f32 v[96:97], v[96:97], v[10:11], v[10:11] op_sel_hi:[1,0,0]
    v_pk_mul_f32 v[226:227], v[226:227], v[234:235]
    v_pk_fma_f32 v[98:99], v[98:99], v[10:11], v[10:11] op_sel_hi:[1,0,0]
    v_pk_mul_f32 v[228:229], v[228:229], v[236:237]
    v_pk_fma_f32 v[100:101], v[100:101], v[10:11], v[10:11] op_sel_hi:[1,0,0]
    v_pk_mul_f32 v[230:231], v[230:231], v[238:239]
    v_pk_fma_f32 v[102:103], v[102:103], v[10:11], v[10:11] op_sel_hi:[1,0,0]
    v_rcp_f32 v96, v96
    v_rcp_f32 v97, v97
    v_rcp_f32 v98, v98
    v_rcp_f32 v99, v99
    v_rcp_f32 v100, v100
    v_rcp_f32 v101, v101
    v_rcp_f32 v102, v102
    v_rcp_f32 v103, v103
    v_pk_mul_f32 v[224:225], v[224:225], v[96:97]
    v_pk_mul_f32 v[226:227], v[226:227], v[98:99]
    v_pk_mul_f32 v[228:229], v[228:229], v[100:101]
    v_pk_mul_f32 v[230:231], v[230:231], v[102:103]
    v_cvt_pk_bf16_f32 v232, v224, v225
    v_cvt_pk_bf16_f32 v233, v226, v227
    v_cvt_pk_bf16_f32 v234, v228, v229
    v_cvt_pk_bf16_f32 v235, v230, v231
    buffer_store_dwordx4 v[232:235], v3, s[8:11], s31 offen offset:3072 sc1
    s_waitcnt vmcnt(3)
    s_mov_b64 exec, 1
    buffer_store_dwordx2 v[16:17], v15, s[8:11], s35 offen sc1
    s_mov_b64 exec, -1
    v_pk_fma_f32 v[240:241], v[80:81], v[12:13], v[240:241] op_sel_hi:[1,0,1]
    v_pk_fma_f32 v[248:249], v[88:89], v[12:13], v[248:249] op_sel_hi:[1,0,1]
    v_pk_mul_f32 v[96:97], v[12:13], v[240:241] op_sel:[1,0] op_sel_hi:[1,1]
    v_pk_fma_f32 v[242:243], v[82:83], v[12:13], v[242:243] op_sel_hi:[1,0,1]
    v_pk_fma_f32 v[250:251], v[90:91], v[12:13], v[250:251] op_sel_hi:[1,0,1]
    v_pk_mul_f32 v[98:99], v[12:13], v[242:243] op_sel:[1,0] op_sel_hi:[1,1]
    v_pk_fma_f32 v[244:245], v[84:85], v[12:13], v[244:245] op_sel_hi:[1,0,1]
    v_pk_fma_f32 v[252:253], v[92:93], v[12:13], v[252:253] op_sel_hi:[1,0,1]
    v_pk_mul_f32 v[100:101], v[12:13], v[244:245] op_sel:[1,0] op_sel_hi:[1,1]
    v_pk_fma_f32 v[246:247], v[86:87], v[12:13], v[246:247] op_sel_hi:[1,0,1]
    v_pk_fma_f32 v[254:255], v[94:95], v[12:13], v[254:255] op_sel_hi:[1,0,1]
    v_pk_mul_f32 v[102:103], v[12:13], v[246:247] op_sel:[1,0] op_sel_hi:[1,1]
    v_exp_f32 v96, v96
    v_exp_f32 v97, v97
    v_exp_f32 v98, v98
    v_exp_f32 v99, v99
    v_exp_f32 v100, v100
    v_exp_f32 v101, v101
    v_exp_f32 v102, v102
    v_exp_f32 v103, v103
    v_pk_mul_f32 v[240:241], v[240:241], v[248:249]
    v_pk_fma_f32 v[96:97], v[96:97], v[14:15], v[14:15] op_sel_hi:[1,0,0]
    v_pk_mul_f32 v[242:243], v[242:243], v[250:251]
    v_pk_fma_f32 v[98:99], v[98:99], v[14:15], v[14:15] op_sel_hi:[1,0,0]
    v_pk_mul_f32 v[244:245], v[244:245], v[252:253]
    v_pk_fma_f32 v[100:101], v[100:101], v[14:15], v[14:15] op_sel_hi:[1,0,0]
    v_pk_mul_f32 v[246:247], v[246:247], v[254:255]
    v_pk_fma_f32 v[102:103], v[102:103], v[14:15], v[14:15] op_sel_hi:[1,0,0]
    v_rcp_f32 v96, v96
    v_rcp_f32 v97, v97
    v_rcp_f32 v98, v98
    v_rcp_f32 v99, v99
    v_rcp_f32 v100, v100
    v_rcp_f32 v101, v101
    v_rcp_f32 v102, v102
    v_rcp_f32 v103, v103
    v_pk_mul_f32 v[240:241], v[240:241], v[96:97]
    v_pk_mul_f32 v[242:243], v[242:243], v[98:99]
    v_pk_mul_f32 v[244:245], v[244:245], v[100:101]
    v_pk_mul_f32 v[246:247], v[246:247], v[102:103]
    v_cvt_pk_bf16_f32 v248, v240, v241
    v_cvt_pk_bf16_f32 v249, v242, v243
    v_cvt_pk_bf16_f32 v250, v244, v245
    v_cvt_pk_bf16_f32 v251, v246, v247
    buffer_store_dwordx4 v[248:251], v3, s[8:11], s30 offen offset:3072 sc1
    ds_write_b64 v120, v[112:113] offset:1032
    ds_write_b64 v120, v[112:113] offset:5248
    ds_write_b64 v120, v[114:115] offset:8
    ds_write_b64 v120, v[114:115] offset:4224
    ds_write_b128 v121, v[116:119]
    ds_write_b64 v121, v[116:117] offset:4216
    ds_write_b64 v121, v[118:119] offset:4224
    v_mov_b32 v6, 163584
    v_mov_b32 v12, 1
    s_mov_b64 exec, 1
    ds_add_u32 v6, v12
    s_mov_b64 exec, -1
    s_setprio 0
A_CONV:
    v_and_b32 v24, 15, v1
    v_lshrrev_b32 v25, 4, v1
    v_and_b32 v26, 3, v24
    v_mul_u32_u24 v26, 4640, v26
    v_lshrrev_b32 v27, 2, v24
    v_lshl_add_u32 v26, v27, 7, v26
    v_lshl_add_u32 v26, v25, 4, v26
    v_mul_u32_u24 v27, 18560, v28
    v_add_u32 v26, v26, v27
    v_and_b32 v31, 1, v2
    v_lshl_add_u32 v26, v31, 8, v26
    v_add_u32 v26, 49152, v26
    v_mul_u32_u24 v5, 61184, v28
    v_add_u32 v5, 86272, v5
    v_lshrrev_b32 v27, 1, v24
    v_sub_u32 v27, v25, v27
    v_add_u32 v27, 7, v27
    v_lshl_add_u32 v27, v27, 4, v5
    v_lshl_add_u32 v27, v31, 8, v27
    v_and_b32 v29, 1, v24
    v_xor_b32 v29, 1, v29
    v_mul_u32_u24 v29, 4224, v29
    v_add_u32 v27, v27, v29
    v_mov_b32 v6, 163584
    s_mov_b32 s39, 16000000
A_KU_L:
    ds_read_b32 v7, v6 offset:0
    s_waitcnt lgkmcnt(0)
    v_cmp_gt_u32 vcc, 8, v7
    s_cbranch_vccz A_KU_D
    s_sub_u32 s39, s39, 1
    s_cbranch_scc1 A_KU_D
    s_sleep 1
    s_branch A_KU_L
A_KU_D:
    ds_read_b128 v[64:67], v27 offset:3584
    ds_read_b128 v[32:35], v26 offset:0
    ds_read_b128 v[68:71], v27 offset:3072
    ds_read_b128 v[36:39], v26 offset:512
    ds_read_b128 v[72:75], v27 offset:2560
    ds_read_b128 v[40:43], v26 offset:1024
    ds_read_b128 v[76:79], v27 offset:2048
    ds_read_b128 v[44:47], v26 offset:1536
    ds_read_b128 v[80:83], v27 offset:1536
    ds_read_b128 v[48:51], v26 offset:2048
    ds_read_b128 v[84:87], v27 offset:1024
    ds_read_b128 v[52:55], v26 offset:2560
    ds_read_b128 v[88:91], v27 offset:512
    ds_read_b128 v[56:59], v26 offset:3072
    ds_read_b128 v[92:95], v27 offset:0
    ds_read_b128 v[60:63], v26 offset:3584
    s_waitcnt lgkmcnt(0)
    v_mfma_f32_16x16x32_bf16 v[200:203], v[32:35], v[64:67], 0
    v_mfma_f32_16x16x32_bf16 v[204:207], v[36:39], v[64:67], 0
    ds_read_b128 v[128:131], v27 offset:3648
    v_mfma_f32_16x16x32_bf16 v[208:211], v[40:43], v[64:67], 0
    v_mfma_f32_16x16x32_bf16 v[212:215], v[44:47], v[64:67], 0
    ds_read_b128 v[96:99], v26 offset:64
    v_mfma_f32_16x16x32_bf16 v[216:219], v[48:51], v[64:67], 0
    v_mfma_f32_16x16x32_bf16 v[220:223], v[52:55], v[64:67], 0
    ds_read_b128 v[132:135], v27 offset:3136
    v_mfma_f32_16x16x32_bf16 v[224:227], v[56:59], v[64:67], 0
    v_mfma_f32_16x16x32_bf16 v[228:231], v[60:63], v[64:67], 0
    ds_read_b128 v[100:103], v26 offset:576
    v_mfma_f32_16x16x32_bf16 v[204:207], v[32:35], v[68:71], v[204:207]
    v_mfma_f32_16x16x32_bf16 v[208:211], v[36:39], v[68:71], v[208:211]
    ds_read_b128 v[136:139], v27 offset:2624
    v_mfma_f32_16x16x32_bf16 v[212:215], v[40:43], v[68:71], v[212:215]
    v_mfma_f32_16x16x32_bf16 v[216:219], v[44:47], v[68:71], v[216:219]
    ds_read_b128 v[104:107], v26 offset:1088
    v_mfma_f32_16x16x32_bf16 v[220:223], v[48:51], v[68:71], v[220:223]
    v_mfma_f32_16x16x32_bf16 v[224:227], v[52:55], v[68:71], v[224:227]
    ds_read_b128 v[140:143], v27 offset:2112
    v_mfma_f32_16x16x32_bf16 v[228:231], v[56:59], v[68:71], v[228:231]
    v_mfma_f32_16x16x32_bf16 v[208:211], v[32:35], v[72:75], v[208:211]
    ds_read_b128 v[108:111], v26 offset:1600
    v_mfma_f32_16x16x32_bf16 v[212:215], v[36:39], v[72:75], v[212:215]
    v_mfma_f32_16x16x32_bf16 v[216:219], v[40:43], v[72:75], v[216:219]
    ds_read_b128 v[144:147], v27 offset:1600
    v_mfma_f32_16x16x32_bf16 v[220:223], v[44:47], v[72:75], v[220:223]
    v_mfma_f32_16x16x32_bf16 v[224:227], v[48:51], v[72:75], v[224:227]
    ds_read_b128 v[112:115], v26 offset:2112
    v_mfma_f32_16x16x32_bf16 v[228:231], v[52:55], v[72:75], v[228:231]
    v_mfma_f32_16x16x32_bf16 v[212:215], v[32:35], v[76:79], v[212:215]
    ds_read_b128 v[148:151], v27 offset:1088
    v_mfma_f32_16x16x32_bf16 v[216:219], v[36:39], v[76:79], v[216:219]
    v_mfma_f32_16x16x32_bf16 v[220:223], v[40:43], v[76:79], v[220:223]
    ds_read_b128 v[116:119], v26 offset:2624
    v_mfma_f32_16x16x32_bf16 v[224:227], v[44:47], v[76:79], v[224:227]
    v_mfma_f32_16x16x32_bf16 v[228:231], v[48:51], v[76:79], v[228:231]
    ds_read_b128 v[152:155], v27 offset:576
    v_mfma_f32_16x16x32_bf16 v[216:219], v[32:35], v[80:83], v[216:219]
    v_mfma_f32_16x16x32_bf16 v[220:223], v[36:39], v[80:83], v[220:223]
    ds_read_b128 v[120:123], v26 offset:3136
    v_mfma_f32_16x16x32_bf16 v[224:227], v[40:43], v[80:83], v[224:227]
    v_mfma_f32_16x16x32_bf16 v[228:231], v[44:47], v[80:83], v[228:231]
    ds_read_b128 v[156:159], v27 offset:64
    v_mfma_f32_16x16x32_bf16 v[220:223], v[32:35], v[84:87], v[220:223]
    v_mfma_f32_16x16x32_bf16 v[224:227], v[36:39], v[84:87], v[224:227]
    ds_read_b128 v[124:127], v26 offset:3648
    v_mfma_f32_16x16x32_bf16 v[228:231], v[40:43], v[84:87], v[228:231]
    v_mfma_f32_16x16x32_bf16 v[224:227], v[32:35], v[88:91], v[224:227]
    v_mfma_f32_16x16x32_bf16 v[228:231], v[36:39], v[88:91], v[228:231]
    v_mfma_f32_16x16x32_bf16 v[228:231], v[32:35], v[92:95], v[228:231]
    s_cmp_eq_u32 s28, 0
    s_cbranch_scc1 A_NOHF
    v_mov_b32 v3, 0
    s_waitcnt vmcnt(0)
    s_mov_b64 exec, 1
    buffer_store_dwordx2 v[16:17], v3, s[8:11], s35 offen offset:8 sc1
    s_mov_b64 exec, -1
A_NOHF:
    s_waitcnt lgkmcnt(0)
    v_mfma_f32_16x16x32_bf16 v[200:203], v[96:99], v[128:131], v[200:203]
    v_mfma_f32_16x16x32_bf16 v[204:207], v[100:103], v[128:131], v[204:207]
    ds_read_b128 v[64:67], v27 offset:3712
    v_mfma_f32_16x16x32_bf16 v[208:211], v[104:107], v[128:131], v[208:211]
    v_mfma_f32_16x16x32_bf16 v[212:215], v[108:111], v[128:131], v[212:215]
    ds_read_b128 v[32:35], v26 offset:128
    v_mfma_f32_16x16x32_bf16 v[216:219], v[112:115], v[128:131], v[216:219]
    v_mfma_f32_16x16x32_bf16 v[220:223], v[116:119], v[128:131], v[220:223]
    ds_read_b128 v[68:71], v27 offset:3200
    v_mfma_f32_16x16x32_bf16 v[224:227], v[120:123], v[128:131], v[224:227]
    v_mfma_f32_16x16x32_bf16 v[228:231], v[124:127], v[128:131], v[228:231]
    ds_read_b128 v[36:39], v26 offset:640
    v_mfma_f32_16x16x32_bf16 v[204:207], v[96:99], v[132:135], v[204:207]
    v_mfma_f32_16x16x32_bf16 v[208:211], v[100:103], v[132:135], v[208:211]
    ds_read_b128 v[72:75], v27 offset:2688
    v_mfma_f32_16x16x32_bf16 v[212:215], v[104:107], v[132:135], v[212:215]
    v_mfma_f32_16x16x32_bf16 v[216:219], v[108:111], v[132:135], v[216:219]
    ds_read_b128 v[40:43], v26 offset:1152
    v_mfma_f32_16x16x32_bf16 v[220:223], v[112:115], v[132:135], v[220:223]
    v_mfma_f32_16x16x32_bf16 v[224:227], v[116:119], v[132:135], v[224:227]
    ds_read_b128 v[76:79], v27 offset:2176
    v_mfma_f32_16x16x32_bf16 v[228:231], v[120:123], v[132:135], v[228:231]
    v_mfma_f32_16x16x32_bf16 v[208:211], v[96:99], v[136:139], v[208:211]
    ds_read_b128 v[44:47], v26 offset:1664
    v_mfma_f32_16x16x32_bf16 v[212:215], v[100:103], v[136:139], v[212:215]
    v_mfma_f32_16x16x32_bf16 v[216:219], v[104:107], v[136:139], v[216:219]
    ds_read_b128 v[80:83], v27 offset:1664
    v_mfma_f32_16x16x32_bf16 v[220:223], v[108:111], v[136:139], v[220:223]
    v_mfma_f32_16x16x32_bf16 v[224:227], v[112:115], v[136:139], v[224:227]
    ds_read_b128 v[48:51], v26 offset:2176
    v_mfma_f32_16x16x32_bf16 v[228:231], v[116:119], v[136:139], v[228:231]
    v_mfma_f32_16x16x32_bf16 v[212:215], v[96:99], v[140:143], v[212:215]
    ds_read_b128 v[84:87], v27 offset:1152
    v_mfma_f32_16x16x32_bf16 v[216:219], v[100:103], v[140:143], v[216:219]
    v_mfma_f32_16x16x32_bf16 v[220:223], v[104:107], v[140:143], v[220:223]
    ds_read_b128 v[52:55], v26 offset:2688
    v_mfma_f32_16x16x32_bf16 v[224:227], v[108:111], v[140:143], v[224:227]
    v_mfma_f32_16x16x32_bf16 v[228:231], v[112:115], v[140:143], v[228:231]
    ds_read_b128 v[88:91], v27 offset:640
    v_mfma_f32_16x16x32_bf16 v[216:219], v[96:99], v[144:147], v[216:219]
    v_mfma_f32_16x16x32_bf16 v[220:223], v[100:103], v[144:147], v[220:223]
    ds_read_b128 v[56:59], v26 offset:3200
    v_mfma_f32_16x16x32_bf16 v[224:227], v[104:107], v[144:147], v[224:227]
    v_mfma_f32_16x16x32_bf16 v[228:231], v[108:111], v[144:147], v[228:231]
    ds_read_b128 v[92:95], v27 offset:128
    v_mfma_f32_16x16x32_bf16 v[220:223], v[96:99], v[148:151], v[220:223]
    v_mfma_f32_16x16x32_bf16 v[224:227], v[100:103], v[148:151], v[224:227]
    ds_read_b128 v[60:63], v26 offset:3712
    v_mfma_f32_16x16x32_bf16 v[228:231], v[104:107], v[148:151], v[228:231]
    v_mfma_f32_16x16x32_bf16 v[224:227], v[96:99], v[152:155], v[224:227]
    v_mfma_f32_16x16x32_bf16 v[228:231], v[100:103], v[152:155], v[228:231]
    v_mfma_f32_16x16x32_bf16 v[228:231], v[96:99], v[156:159], v[228:231]
    s_waitcnt lgkmcnt(0)
    v_mfma_f32_16x16x32_bf16 v[200:203], v[32:35], v[64:67], v[200:203]
    v_mfma_f32_16x16x32_bf16 v[204:207], v[36:39], v[64:67], v[204:207]
    ds_read_b128 v[128:131], v27 offset:3776
    v_mfma_f32_16x16x32_bf16 v[208:211], v[40:43], v[64:67], v[208:211]
    v_mfma_f32_16x16x32_bf16 v[212:215], v[44:47], v[64:67], v[212:215]
    ds_read_b128 v[96:99], v26 offset:192
    v_mfma_f32_16x16x32_bf16 v[216:219], v[48:51], v[64:67], v[216:219]
    v_mfma_f32_16x16x32_bf16 v[220:223], v[52:55], v[64:67], v[220:223]
    ds_read_b128 v[132:135], v27 offset:3264
    v_mfma_f32_16x16x32_bf16 v[224:227], v[56:59], v[64:67], v[224:227]
    v_mfma_f32_16x16x32_bf16 v[228:231], v[60:63], v[64:67], v[228:231]
    ds_read_b128 v[100:103], v26 offset:704
    v_mfma_f32_16x16x32_bf16 v[204:207], v[32:35], v[68:71], v[204:207]
    v_mfma_f32_16x16x32_bf16 v[208:211], v[36:39], v[68:71], v[208:211]
    ds_read_b128 v[136:139], v27 offset:2752
    v_mfma_f32_16x16x32_bf16 v[212:215], v[40:43], v[68:71], v[212:215]
    v_mfma_f32_16x16x32_bf16 v[216:219], v[44:47], v[68:71], v[216:219]
    ds_read_b128 v[104:107], v26 offset:1216
    v_mfma_f32_16x16x32_bf16 v[220:223], v[48:51], v[68:71], v[220:223]
    v_mfma_f32_16x16x32_bf16 v[224:227], v[52:55], v[68:71], v[224:227]
    ds_read_b128 v[140:143], v27 offset:2240
    v_mfma_f32_16x16x32_bf16 v[228:231], v[56:59], v[68:71], v[228:231]
    v_mfma_f32_16x16x32_bf16 v[208:211], v[32:35], v[72:75], v[208:211]
    ds_read_b128 v[108:111], v26 offset:1728
    v_mfma_f32_16x16x32_bf16 v[212:215], v[36:39], v[72:75], v[212:215]
    v_mfma_f32_16x16x32_bf16 v[216:219], v[40:43], v[72:75], v[216:219]
    ds_read_b128 v[144:147], v27 offset:1728
    v_mfma_f32_16x16x32_bf16 v[220:223], v[44:47], v[72:75], v[220:223]
    v_mfma_f32_16x16x32_bf16 v[224:227], v[48:51], v[72:75], v[224:227]
    ds_read_b128 v[112:115], v26 offset:2240
    v_mfma_f32_16x16x32_bf16 v[228:231], v[52:55], v[72:75], v[228:231]
    v_mfma_f32_16x16x32_bf16 v[212:215], v[32:35], v[76:79], v[212:215]
    ds_read_b128 v[148:151], v27 offset:1216
    v_mfma_f32_16x16x32_bf16 v[216:219], v[36:39], v[76:79], v[216:219]
    v_mfma_f32_16x16x32_bf16 v[220:223], v[40:43], v[76:79], v[220:223]
    ds_read_b128 v[116:119], v26 offset:2752
    v_mfma_f32_16x16x32_bf16 v[224:227], v[44:47], v[76:79], v[224:227]
    v_mfma_f32_16x16x32_bf16 v[228:231], v[48:51], v[76:79], v[228:231]
    ds_read_b128 v[152:155], v27 offset:704
    v_mfma_f32_16x16x32_bf16 v[216:219], v[32:35], v[80:83], v[216:219]
    v_mfma_f32_16x16x32_bf16 v[220:223], v[36:39], v[80:83], v[220:223]
    ds_read_b128 v[120:123], v26 offset:3264
    v_mfma_f32_16x16x32_bf16 v[224:227], v[40:43], v[80:83], v[224:227]
    v_mfma_f32_16x16x32_bf16 v[228:231], v[44:47], v[80:83], v[228:231]
    ds_read_b128 v[156:159], v27 offset:192
    v_mfma_f32_16x16x32_bf16 v[220:223], v[32:35], v[84:87], v[220:223]
    v_mfma_f32_16x16x32_bf16 v[224:227], v[36:39], v[84:87], v[224:227]
    ds_read_b128 v[124:127], v26 offset:3776
    v_mfma_f32_16x16x32_bf16 v[228:231], v[40:43], v[84:87], v[228:231]
    v_mfma_f32_16x16x32_bf16 v[224:227], v[32:35], v[88:91], v[224:227]
    v_mfma_f32_16x16x32_bf16 v[228:231], v[36:39], v[88:91], v[228:231]
    v_mfma_f32_16x16x32_bf16 v[228:231], v[32:35], v[92:95], v[228:231]
    s_waitcnt lgkmcnt(0)
    v_mfma_f32_16x16x32_bf16 v[200:203], v[96:99], v[128:131], v[200:203]
    v_mfma_f32_16x16x32_bf16 v[204:207], v[100:103], v[128:131], v[204:207]
    v_lshlrev_b32 v10, 2, v2
    v_add_u32 v10, 163600, v10
    v_mov_b32 v12, 2
    ds_write_b32 v10, v12
    v_mfma_f32_16x16x32_bf16 v[208:211], v[104:107], v[128:131], v[208:211]
    v_mfma_f32_16x16x32_bf16 v[212:215], v[108:111], v[128:131], v[212:215]
    v_mul_u32_u24 v26, 18560, v28
    v_add_u32 v26, 49152, v26
    v_lshl_add_u32 v8, v1, 4, v26
    v_lshl_add_u32 v26, v1, 3, v26
    v_mfma_f32_16x16x32_bf16 v[216:219], v[112:115], v[128:131], v[216:219]
    v_mfma_f32_16x16x32_bf16 v[220:223], v[116:119], v[128:131], v[220:223]
    v_lshl_add_u32 v26, v31, 11, v26
    ds_read_b64 v[48:49], v26 offset:14304
    ds_read_b64 v[50:51], v26 offset:14816
    ds_read_b64 v[52:53], v26 offset:15328
    ds_read_b64 v[54:55], v26 offset:15840
    v_mfma_f32_16x16x32_bf16 v[224:227], v[120:123], v[128:131], v[224:227]
    v_mfma_f32_16x16x32_bf16 v[228:231], v[124:127], v[128:131], v[228:231]
    s_mov_b32 s33, 4640
    v_xor_b32 v9, 1, v31
    v_mad_u32_u24 v9, v9, s33, v8
    v_mad_u32_u24 v8, v31, s33, v8
    v_mfma_f32_16x16x32_bf16 v[204:207], v[96:99], v[132:135], v[204:207]
    v_mfma_f32_16x16x32_bf16 v[208:211], v[100:103], v[132:135], v[208:211]
    v_xor_b32 v11, 4, v10
    v_mov_b32 v13, 3
    v_lshlrev_b32 v27, 3, v1
    v_lshl_add_u32 v27, v2, 11, v27
    v_mfma_f32_16x16x32_bf16 v[212:215], v[104:107], v[132:135], v[212:215]
    v_mfma_f32_16x16x32_bf16 v[216:219], v[108:111], v[132:135], v[216:219]
    s_lshl_b32 s31, s77, 13
    s_add_u32 s31, s31, 12582912
    s_mov_b32 s38, 0xffff0000
    v_lshlrev_b32 v30, 16, v30
    s_waitcnt lgkmcnt(0)
    v_mfma_f32_16x16x32_bf16 v[220:223], v[112:115], v[132:135], v[220:223]
    v_mfma_f32_16x16x32_bf16 v[224:227], v[116:119], v[132:135], v[224:227]
    v_lshlrev_b32 v64, 16, v48
    v_and_b32 v65, s38, v48
    v_lshlrev_b32 v66, 16, v49
    v_and_b32 v67, s38, v49
    v_mfma_f32_16x16x32_bf16 v[228:231], v[120:123], v[132:135], v[228:231]
    v_mfma_f32_16x16x32_bf16 v[208:211], v[96:99], v[136:139], v[208:211]
    v_mul_f32 v64, v30, v64
    v_mul_f32 v65, v30, v65
    v_mul_f32 v66, v30, v66
    v_mul_f32 v67, v30, v67
    v_cvt_pk_bf16_f32 v48, v64, v65
    v_cvt_pk_bf16_f32 v49, v66, v67
    v_mfma_f32_16x16x32_bf16 v[212:215], v[100:103], v[136:139], v[212:215]
    v_mfma_f32_16x16x32_bf16 v[216:219], v[104:107], v[136:139], v[216:219]
    v_lshlrev_b32 v64, 16, v48
    v_and_b32 v65, s38, v48
    v_lshlrev_b32 v66, 16, v49
    v_and_b32 v67, s38, v49
    v_mfma_f32_16x16x32_bf16 v[220:223], v[108:111], v[136:139], v[220:223]
    v_mfma_f32_16x16x32_bf16 v[224:227], v[112:115], v[136:139], v[224:227]
    v_lshlrev_b32 v68, 16, v50
    v_and_b32 v69, s38, v50
    v_lshlrev_b32 v70, 16, v51
    v_and_b32 v71, s38, v51
    v_mfma_f32_16x16x32_bf16 v[228:231], v[116:119], v[136:139], v[228:231]
    v_mfma_f32_16x16x32_bf16 v[212:215], v[96:99], v[140:143], v[212:215]
    v_mul_f32 v68, v30, v68
    v_mul_f32 v69, v30, v69
    v_mul_f32 v70, v30, v70
    v_mul_f32 v71, v30, v71
    v_cvt_pk_bf16_f32 v50, v68, v69
    v_cvt_pk_bf16_f32 v51, v70, v71
    v_mfma_f32_16x16x32_bf16 v[216:219], v[100:103], v[140:143], v[216:219]
    v_mfma_f32_16x16x32_bf16 v[220:223], v[104:107], v[140:143], v[220:223]
    v_lshlrev_b32 v68, 16, v50
    v_and_b32 v69, s38, v50
    v_lshlrev_b32 v70, 16, v51
    v_and_b32 v71, s38, v51
    v_mfma_f32_16x16x32_bf16 v[224:227], v[108:111], v[140:143], v[224:227]
    v_mfma_f32_16x16x32_bf16 v[228:231], v[112:115], v[140:143], v[228:231]
    v_lshlrev_b32 v72, 16, v52
    v_and_b32 v73, s38, v52
    v_lshlrev_b32 v74, 16, v53
    v_and_b32 v75, s38, v53
    v_mfma_f32_16x16x32_bf16 v[216:219], v[96:99], v[144:147], v[216:219]
    v_mfma_f32_16x16x32_bf16 v[220:223], v[100:103], v[144:147], v[220:223]
    v_mul_f32 v72, v30, v72
    v_mul_f32 v73, v30, v73
    v_mul_f32 v74, v30, v74
    v_mul_f32 v75, v30, v75
    v_cvt_pk_bf16_f32 v52, v72, v73
    v_cvt_pk_bf16_f32 v53, v74, v75
    v_mfma_f32_16x16x32_bf16 v[224:227], v[104:107], v[144:147], v[224:227]
    v_mfma_f32_16x16x32_bf16 v[228:231], v[108:111], v[144:147], v[228:231]
    v_lshlrev_b32 v72, 16, v52
    v_and_b32 v73, s38, v52
    v_lshlrev_b32 v74, 16, v53
    v_and_b32 v75, s38, v53
    v_mfma_f32_16x16x32_bf16 v[220:223], v[96:99], v[148:151], v[220:223]
    v_mfma_f32_16x16x32_bf16 v[224:227], v[100:103], v[148:151], v[224:227]
    v_lshlrev_b32 v76, 16, v54
    v_and_b32 v77, s38, v54
    v_lshlrev_b32 v78, 16, v55
    v_and_b32 v79, s38, v55
    v_mfma_f32_16x16x32_bf16 v[228:231], v[104:107], v[148:151], v[228:231]
    v_mfma_f32_16x16x32_bf16 v[224:227], v[96:99], v[152:155], v[224:227]
    v_mul_f32 v76, v30, v76
    v_mul_f32 v77, v30, v77
    v_mul_f32 v78, v30, v78
    v_mul_f32 v79, v30, v79
    v_cvt_pk_bf16_f32 v54, v76, v77
    v_cvt_pk_bf16_f32 v55, v78, v79
    v_mfma_f32_16x16x32_bf16 v[228:231], v[100:103], v[152:155], v[228:231]
    v_mfma_f32_16x16x32_bf16 v[228:231], v[96:99], v[156:159], v[228:231]
    v_lshlrev_b32 v76, 16, v54
    v_and_b32 v77, s38, v54
    v_lshlrev_b32 v78, 16, v55
    v_and_b32 v79, s38, v55
    s_mov_b32 s39, 16000000
A_P0_L:
    ds_read_b32 v7, v11 offset:0
    s_waitcnt lgkmcnt(0)
    v_cmp_gt_u32 vcc, 2, v7
    s_cbranch_vccz A_P0_D
    s_sub_u32 s39, s39, 1
    s_cbranch_scc1 A_P0_D
    s_sleep 1
    s_branch A_P0_L
A_P0_D:
    s_and_b32 s30, s29, 1
    s_cmp_eq_u32 s30, 1
    s_nop 3
    s_cbranch_scc1 A_ODD
    ds_write_b128 v8, v[216:219] offset:0
    ds_write_b128 v8, v[220:223] offset:1024
    ds_write_b128 v8, v[224:227] offset:2048
    ds_write_b128 v8, v[228:231] offset:3072
    ds_write_b32 v10, v13
    s_branch A_J
A_ODD:
    ds_write_b128 v8, v[200:203] offset:0
    ds_write_b128 v8, v[204:207] offset:1024
    ds_write_b128 v8, v[208:211] offset:2048
    ds_write_b128 v8, v[212:215] offset:3072
    ds_write_b32 v10, v13
    v_mov_b32 v200, v216
    v_mov_b32 v201, v217
    v_mov_b32 v202, v218
    v_mov_b32 v203, v219
    v_mov_b32 v204, v220
    v_mov_b32 v205, v221
    v_mov_b32 v206, v222
    v_mov_b32 v207, v223
    v_mov_b32 v208, v224
    v_mov_b32 v209, v225
    v_mov_b32 v210, v226
    v_mov_b32 v211, v227
    v_mov_b32 v212, v228
    v_mov_b32 v213, v229
    v_mov_b32 v214, v230
    v_mov_b32 v215, v231
A_J:
    s_mov_b32 s39, 16000000
A_PR_L:
    ds_read_b32 v7, v11 offset:0
    s_waitcnt lgkmcnt(0)
    v_cmp_gt_u32 vcc, 3, v7
    s_cbranch_vccz A_PR_D
    s_sub_u32 s39, s39, 1
    s_cbranch_scc1 A_PR_D
    s_sleep 1
    s_branch A_PR_L
A_PR_D:
    ds_read_b128 v[32:35], v9 offset:0
    ds_read_b128 v[36:39], v9 offset:1024
    ds_read_b128 v[40:43], v9 offset:2048
    ds_read_b128 v[44:47], v9 offset:3072
    s_waitcnt lgkmcnt(3)
    v_add_f32 v200, v200, v32
    v_add_f32 v201, v201, v33
    v_add_f32 v202, v202, v34
    v_add_f32 v203, v203, v35
    v_cvt_pk_bf16_f32 v32, v200, v201
    v_cvt_pk_bf16_f32 v33, v202, v203
    v_lshlrev_b32 v200, 16, v32
    v_and_b32 v201, s38, v32
    v_lshlrev_b32 v202, 16, v33
    v_and_b32 v203, s38, v33
    v_add_f32 v200, v200, v64
    v_add_f32 v201, v201, v65
    v_add_f32 v202, v202, v66
    v_add_f32 v203, v203, v67
    v_cvt_pk_bf16_f32 v32, v200, v201
    v_cvt_pk_bf16_f32 v33, v202, v203
    buffer_store_dwordx2 v[32:33], v27, s[8:11], s31 offen offset:0 sc1
    s_waitcnt lgkmcnt(2)
    v_add_f32 v204, v204, v36
    v_add_f32 v205, v205, v37
    v_add_f32 v206, v206, v38
    v_add_f32 v207, v207, v39
    v_cvt_pk_bf16_f32 v36, v204, v205
    v_cvt_pk_bf16_f32 v37, v206, v207
    v_lshlrev_b32 v204, 16, v36
    v_and_b32 v205, s38, v36
    v_lshlrev_b32 v206, 16, v37
    v_and_b32 v207, s38, v37
    v_add_f32 v204, v204, v68
    v_add_f32 v205, v205, v69
    v_add_f32 v206, v206, v70
    v_add_f32 v207, v207, v71
    v_cvt_pk_bf16_f32 v36, v204, v205
    v_cvt_pk_bf16_f32 v37, v206, v207
    buffer_store_dwordx2 v[36:37], v27, s[8:11], s31 offen offset:512 sc1
    s_waitcnt lgkmcnt(1)
    v_add_f32 v208, v208, v40
    v_add_f32 v209, v209, v41
    v_add_f32 v210, v210, v42
    v_add_f32 v211, v211, v43
    v_cvt_pk_bf16_f32 v40, v208, v209
    v_cvt_pk_bf16_f32 v41, v210, v211
    v_lshlrev_b32 v208, 16, v40
    v_and_b32 v209, s38, v40
    v_lshlrev_b32 v210, 16, v41
    v_and_b32 v211, s38, v41
    v_add_f32 v208, v208, v72
    v_add_f32 v209, v209, v73
    v_add_f32 v210, v210, v74
    v_add_f32 v211, v211, v75
    v_cvt_pk_bf16_f32 v40, v208, v209
    v_cvt_pk_bf16_f32 v41, v210, v211
    buffer_store_dwordx2 v[40:41], v27, s[8:11], s31 offen offset:1024 sc1
    s_waitcnt lgkmcnt(0)
    v_add_f32 v212, v212, v44
    v_add_f32 v213, v213, v45
    v_add_f32 v214, v214, v46
    v_add_f32 v215, v215, v47
    v_cvt_pk_bf16_f32 v44, v212, v213
    v_cvt_pk_bf16_f32 v45, v214, v215
    v_lshlrev_b32 v212, 16, v44
    v_and_b32 v213, s38, v44
    v_lshlrev_b32 v214, 16, v45
    v_and_b32 v215, s38, v45
    v_add_f32 v212, v212, v76
    v_add_f32 v213, v213, v77
    v_add_f32 v214, v214, v78
    v_add_f32 v215, v215, v79
    v_cvt_pk_bf16_f32 v44, v212, v213
    v_cvt_pk_bf16_f32 v45, v214, v215
    buffer_store_dwordx2 v[44:45], v27, s[8:11], s31 offen offset:1536 sc1
    s_lshl_b32 s31, s77, 7
    s_lshl_b32 s30, s29, 3
    s_add_u32 s31, s31, s30
    s_add_u32 s31, s31, 524288
    v_mov_b32 v3, 0
    v_cmp_eq_u32 vcc, 0, v1
    s_waitcnt vmcnt(0)
    s_and_saveexec_b64 s[74:75], vcc
    buffer_store_dwordx2 v[16:17], v3, s[8:11], s31 offen sc1
    s_mov_b64 exec, s[74:75]
END:
    s_endpgm
KEND:

.section .rodata,"a"
.p2align 6
.amdhsa_kernel parallel_sum__ssm_conv_s4d__glu_gated_swiglu__prompt_kernel
  .amdhsa_next_free_vgpr 256
  .amdhsa_next_free_sgpr 102
  .amdhsa_accum_offset 256
  .amdhsa_group_segment_fixed_size 0
  .amdhsa_kernarg_size 112
  .amdhsa_user_sgpr_count 2
  .amdhsa_user_sgpr_kernarg_segment_ptr 1
  .amdhsa_system_sgpr_workgroup_id_x 1
.end_amdhsa_kernel
```
